```python
import torch

def _softmax(x, axis=-1):
    return torch.softmax(x, dim=axis)

def _gelu(x):
    return torch.nn.functional.gelu(x, approximate='tanh')

def _silu(x):
    return torch.nn.functional.silu(x)

def _sigmoid(x):
    return torch.sigmoid(x)

def _layernorm(x, axis=-1, eps=1e-05):
    m = x.mean(dim=axis, keepdim=True)
    v = x.var(dim=axis, keepdim=True, unbiased=False)
    return (x - m) / torch.sqrt(v + eps)

def _scatter_add(tgt, idx, src, axis=0):
    return tgt.clone().index_add_(axis, idx, src)

def _segment_sum(src, seg, n):
    out = torch.zeros((n,) + src.shape[1:], dtype=src.dtype)
    return out.index_add_(0, seg, src)

def _pad(x, pw):
    flat = tuple((v for pair in reversed(pw) for v in pair))
    return torch.nn.functional.pad(x, flat)
kernel_name = 'adaLN_cond__gqa_block_cached__swiglu_ffn__decode'

def setup_inputs():

    _w = lambda a: (lambda t: t.to(torch.bfloat16) if t.is_floating_point() else t)(torch.as_tensor(a))

    def _A_setup():
        B, Sq, D = (1, 1, 640)
        Hq, Hkv, Sk, Dh = (32, 32, 16384, 128)
        assert Hq % Hkv == 0, (Hq, Hkv)
        return {'x': _w((lambda *s: torch.randn(*s, dtype=torch.bfloat16) * 0.05)(B, Sq, D)), 'k_cache': _w((lambda *s: torch.randn(*s, dtype=torch.bfloat16) * 0.8)(B, Hkv, Sk, Dh)), 'v_cache': _w((lambda *s: torch.randn(*s, dtype=torch.bfloat16) * 1.6)(B, Hkv, Sk, Dh)), 'wq': _w((lambda *s: torch.randn(*s, dtype=torch.bfloat16) * 0.8)(D, Hq * Dh) * D ** (-0.5)), 'wo': _w((lambda *s: torch.randn(*s, dtype=torch.bfloat16) * 1.6)(Hq * Dh, D) * (Hq * Dh) ** (-0.5))}
    _A_in = _A_setup()

    def _B_setup():
        B, S, D, F = (1, 1, 640, 1728)
        return {'x': _w((lambda *s: torch.randn(*s, dtype=torch.bfloat16) * 0.05)(B, S, D)), 'w_gate': _w((lambda *s: torch.randn(*s, dtype=torch.bfloat16) * 0.05)(D, F)), 'w_up': _w((lambda *s: torch.randn(*s, dtype=torch.bfloat16) * 0.05)(D, F)), 'w_down': _w((lambda *s: torch.randn(*s, dtype=torch.bfloat16) * 0.05)(F, D))}
    _B_in = _B_setup()
    return {'A_x': _A_in['x'], 'A_k_cache': _A_in['k_cache'], 'A_v_cache': _A_in['v_cache'], 'A_wq': _A_in['wq'], 'A_wo': _A_in['wo'], 'B_x': _B_in['x'], 'B_w_gate': _B_in['w_gate'], 'B_w_up': _B_in['w_up'], 'B_w_down': _B_in['w_down'], 'c': _w((lambda *s: torch.randn(*s, dtype=torch.bfloat16) * 0.2)(1, 640) * 8.0), 'w_mod': _w((lambda *s: torch.randn(*s, dtype=torch.bfloat16) * 0.2)(640, 6 * 640) * 640 ** (-0.5) * 8.0)}

def reference(A_x, A_k_cache, A_v_cache, A_wq, A_wo, B_x, B_w_gate, B_w_up, B_w_down, c, w_mod):

    def _A_ref(x, k_cache, v_cache, wq, wo):
        B, Sq, D = x.shape
        Hq, Dh = (32, 128)
        Hkv = k_cache.shape[1]
        rep = Hq // Hkv
        q = (lambda x, *d: x.permute(*d))((x @ wq).reshape(B, Sq, Hq, Dh), 0, 2, 1, 3)
        k = (lambda x, n, axis: torch.repeat_interleave(x, n, dim=axis))(k_cache, rep, axis=1)
        v = (lambda x, n, axis: torch.repeat_interleave(x, n, dim=axis))(v_cache, rep, axis=1)
        scores = torch.einsum('bhqd,bhkd->bhqk', q, k) * Dh ** (-0.5)
        p = _softmax(scores, axis=-1)
        o = torch.einsum('bhqk,bhkd->bhqd', p, v)
        return (lambda x, *d: x.permute(*d))(o, 0, 2, 1, 3).reshape(B, Sq, Hq * Dh) @ wo

    def _B_ref(x, w_gate, w_up, w_down):
        g = _silu(x @ w_gate)
        u = x @ w_up
        return g * u @ w_down
    x = A_x
    mod = (_silu(c) @ w_mod).reshape(c.shape[0], 6, 1, -1)
    sa, ca, ga, sb, cb, gb = (mod[:, 0].clone(), mod[:, 1].clone(), mod[:, 2].clone(), mod[:, 3].clone(), mod[:, 4].clone(), mod[:, 5].clone())
    h = _layernorm(x, axis=-1) * (1 + ca) + sa
    x = x + ga * _A_ref(h, A_k_cache, A_v_cache, A_wq, A_wo)
    h = _layernorm(x, axis=-1) * (1 + cb) + sb
    x = x + gb * _B_ref(h, B_w_gate, B_w_up, B_w_down)
    return x
```

```asm
; @launch grid=(256,1,1) block=(512,1,1) lds=140288
.amdgcn_target "amdgcn-amd-amdhsa--gfx950"
.text
.globl adaLN_cond__gqa_block_cached__swiglu_ffn__decode_kernel
.p2align 8
.type adaLN_cond__gqa_block_cached__swiglu_ffn__decode_kernel,@function
adaLN_cond__gqa_block_cached__swiglu_ffn__decode_kernel:
    s_cmp_ge_u32 s2, 256
    s_cbranch_scc1 L_end
    v_readfirstlane_b32 s3, v0
    v_and_b32 v1, 63, v0
    v_lshlrev_b32 v11, 4, v1
    s_cmp_ge_u32 s3, 448
    s_cbranch_scc1 L_z
L_e1:
    s_load_dwordx16 s[36:51], s[0:1], 0
    s_load_dwordx8 s[52:59], s[0:1], 64
    s_load_dwordx4 s[60:63], s[0:1], 96
    s_getpc_b64 s[6:7]
L_pc:
    s_cmp_ge_u32 s2, 32
    s_cbranch_scc1 L_nopf
    s_lshl_b32 s4, s2, 10
    s_and_b32 s4, s4, 0x6000
    v_lshlrev_b32 v2, 4, v0
    v_add_u32 v2, s4, v2
    v_min_u32 v2, L_codeend-L_pc-16, v2
    global_load_dwordx4 v[244:247], v2, s[6:7]
L_nopf:
    v_and_b32 v2, 15, v0
    v_bfe_u32 v3, v0, 4, 2
    s_lshr_b32 s4, s2, 3
    s_add_u32 s5, s2, 5
    s_and_b32 s5, s5, 7
    s_lshr_b32 s3, s3, 6
    v_and_b32 v4, 1, v2
    v_lshlrev_b32 v4, 4, v4
    v_mov_b32 v5, 0xffff
    v_lshlrev_b32 v5, v4, v5
    v_lshrrev_b32 v4, 1, v2
    v_cmp_eq_u32 vcc, 0, v4
    s_nop 1
    v_cndmask_b32 v6, 0, v5, vcc
    v_cmp_eq_u32 vcc, 1, v4
    s_nop 1
    v_cndmask_b32 v7, 0, v5, vcc
    v_cmp_eq_u32 vcc, 2, v4
    s_nop 1
    v_cndmask_b32 v8, 0, v5, vcc
    v_cmp_eq_u32 vcc, 3, v4
    s_nop 1
    v_cndmask_b32 v9, 0, v5, vcc
    s_barrier
    s_cmp_ge_u32 s3, 4
    s_cbranch_scc1 L_svc
    s_lshl_b32 s6, s4, 22
    s_lshl_b32 s7, s5, 19
    s_lshl_b32 s66, s3, 12
    s_add_u32 s66, s66, s7
    s_and_b32 s89, s5, 3
    s_lshl_b32 s89, s89, 17
    s_xor_b32 s26, s66, s89
    s_mov_b32 s10, 0x400000
    s_mov_b32 s11, 0x20000
    s_mov_b32 s14, 0x400000
    s_mov_b32 s15, 0x20000
    s_add_u32 s7, s4, 11
    s_and_b32 s7, s7, 31
    s_cmp_lt_u32 s7, 16
    s_cselect_b32 s7, 3, 2
    s_cmp_lt_u32 s5, s7
    s_cselect_b32 s28, 2, 0
    s_cmp_lt_u32 s5, 5
    s_cbranch_scc1 L_h1
    s_cmp_lt_u32 s4, 15
    s_cselect_b32 s7, 6, 5
    s_cmp_lt_u32 s4, 5
    s_cselect_b32 s7, 7, s7
    s_cselect_b32 s29, 0, 2
    s_cmp_lt_u32 s5, s7
    s_cselect_b32 s28, 1, 0
    s_cmp_eq_u32 s5, 7
    s_cselect_b32 s28, s29, s28
    s_cmp_lt_u32 s4, 15
    s_cbranch_scc1 L_h1
    s_sleep 30
L_h1:
    s_mov_b32 s95, s28
L_h2:
    s_waitcnt lgkmcnt(0)
    s_add_u32 s8, s38, s6
    s_addc_u32 s9, s39, 0
    s_add_u32 s12, s40, s6
    s_addc_u32 s13, s41, 0
    s_mov_b32 s33, s66
    buffer_load_dwordx4 v[32:35], v11, s[8:11], s26 offen offset:0 nt
    buffer_load_dwordx4 v[36:39], v11, s[8:11], s26 offen offset:1024 nt
    buffer_load_dwordx4 v[40:43], v11, s[8:11], s26 offen offset:2048 nt
    buffer_load_dwordx4 v[44:47], v11, s[8:11], s26 offen offset:3072 nt
    s_add_u32 s66, s66, 16384
    s_xor_b32 s26, s66, s89
    buffer_load_dwordx4 v[48:51], v11, s[8:11], s26 offen offset:0 nt
    buffer_load_dwordx4 v[52:55], v11, s[8:11], s26 offen offset:1024 nt
    s_branch L_str
L_z:
    v_mov_b32 v12, 0
    v_mov_b32 v13, 0
    v_mov_b32 v14, 0
    v_mov_b32 v15, 0
    ds_write_b128 v11, v[12:15]
    ds_write_b128 v11, v[12:15] offset:1024
    s_waitcnt lgkmcnt(0)
    s_branch L_e1
L_hold:
    s_mov_b32 s35, 2155172
    v_mov_b32 v16, 44
Lw_1:
    s_sub_u32 s35, s35, 1
    s_cbranch_scc1 Lx_2
    ds_read_b32 v17, v16
    s_waitcnt lgkmcnt(0)
    v_readfirstlane_b32 s34, v17
    s_nop 0
    s_cmp_ge_u32 s34, s28
    s_cbranch_scc1 Lx_2
    s_sleep 2
    s_branch Lw_1
Lx_2:
    s_branch L_h2
L_svc:
    s_waitcnt lgkmcnt(0)
    s_load_dword s64, s[62:63], 0
    s_sub_u32 s3, s3, 4
    s_mov_b32 s16, s62
    s_mov_b32 s17, s63
    s_mov_b32 s18, 2097152
    s_mov_b32 s19, 0x20000
    s_setprio 2
    v_lshlrev_b32 v14, 1, v1
    v_lshrrev_b32 v10, 1, v11
    s_cmp_ge_u32 s3, 2
    s_cbranch_scc1 L_t0
    s_cmp_lt_u32 s5, 5
    s_cbranch_scc1 L_stB
    s_cmp_eq_u32 s3, 1
    s_cbranch_scc1 L_m0
    s_cmp_lt_u32 s4, 15
    s_cbranch_scc1 L_q0
    s_mul_i32 s6, s4, 3
    s_add_u32 s6, s6, s5
    s_sub_u32 s6, s6, 50
    s_cmp_ge_u32 s6, 50
    s_cbranch_scc1 L_q0
    s_mul_i32 s7, s6, 205
    s_lshr_b32 s7, s7, 11
    s_mul_i32 s24, s7, 10
    s_sub_u32 s6, s6, s24
    s_mul_i32 s24, s7, 983040
    s_lshl_b32 s27, s6, 7
    s_add_u32 s24, s24, s27
    s_lshl_b32 s27, s7, 8
    s_mov_b32 s28, 1
    s_movk_i32 s29, 1280
    s_mul_i32 s33, s6, 5
    s_add_u32 s33, s33, s7
    s_lshl_b32 s33, s33, 10
    s_add_u32 s33, s33, 65536
L_am:
    s_mov_b32 s8, s56
    s_mov_b32 s9, s57
    s_mov_b32 s10, 4915200
    s_mov_b32 s11, 0x20000
    s_mov_b32 s12, s54
    s_mov_b32 s13, s55
    s_mov_b32 s14, 1280
    s_mov_b32 s15, 0x20000
    v_and_b32 v15, 7, v2
    v_lshlrev_b32 v15, 4, v15
    v_lshrrev_b32 v5, 3, v2
    v_mul_u32_u24 v5, s29, v5
    v_add_u32 v15, v15, v5
    v_mul_u32_u24 v5, 122880, v3
    v_add_u32 v15, v15, v5
    v_mov_b32 v16, 0
    v_mov_b32 v17, 0
    v_mov_b32 v18, 0
    v_mov_b32 v19, 0
L_aml:
    buffer_load_ushort v32, v14, s[12:15], s27 offen
    buffer_load_ushort v33, v14, s[12:15], s27 offen offset:128
    s_mov_b32 s6, s24
    buffer_load_dwordx4 v[64:67], v15, s[8:11], s6 offen nt
    s_add_u32 s6, s6, 7680
    buffer_load_dwordx4 v[68:71], v15, s[8:11], s6 offen nt
    s_add_u32 s6, s6, 7680
    buffer_load_dwordx4 v[72:75], v15, s[8:11], s6 offen nt
    s_add_u32 s6, s6, 7680
    buffer_load_dwordx4 v[76:79], v15, s[8:11], s6 offen nt
    s_add_u32 s6, s6, 7680
    buffer_load_dwordx4 v[80:83], v15, s[8:11], s6 offen nt
    s_add_u32 s6, s6, 7680
    buffer_load_dwordx4 v[84:87], v15, s[8:11], s6 offen nt
    s_add_u32 s6, s6, 7680
    buffer_load_dwordx4 v[88:91], v15, s[8:11], s6 offen nt
    s_add_u32 s6, s6, 7680
    buffer_load_dwordx4 v[92:95], v15, s[8:11], s6 offen nt
    s_add_u32 s6, s6, 7680
    buffer_load_dwordx4 v[96:99], v15, s[8:11], s6 offen nt
    s_add_u32 s6, s6, 7680
    buffer_load_dwordx4 v[100:103], v15, s[8:11], s6 offen nt
    s_add_u32 s6, s6, 7680
    buffer_load_dwordx4 v[104:107], v15, s[8:11], s6 offen nt
    s_add_u32 s6, s6, 7680
    buffer_load_dwordx4 v[108:111], v15, s[8:11], s6 offen nt
    s_add_u32 s6, s6, 7680
    buffer_load_dwordx4 v[112:115], v15, s[8:11], s6 offen nt
    s_add_u32 s6, s6, 7680
    buffer_load_dwordx4 v[116:119], v15, s[8:11], s6 offen nt
    s_add_u32 s6, s6, 7680
    buffer_load_dwordx4 v[120:123], v15, s[8:11], s6 offen nt
    s_add_u32 s6, s6, 7680
    buffer_load_dwordx4 v[124:127], v15, s[8:11], s6 offen nt
    s_add_u32 s6, s6, 376320
    buffer_load_dwordx4 v[128:131], v15, s[8:11], s6 offen nt
    s_add_u32 s6, s6, 7680
    buffer_load_dwordx4 v[132:135], v15, s[8:11], s6 offen nt
    s_add_u32 s6, s6, 7680
    buffer_load_dwordx4 v[136:139], v15, s[8:11], s6 offen nt
    s_add_u32 s6, s6, 7680
    buffer_load_dwordx4 v[140:143], v15, s[8:11], s6 offen nt
    s_add_u32 s6, s6, 7680
    buffer_load_dwordx4 v[144:147], v15, s[8:11], s6 offen nt
    s_add_u32 s6, s6, 7680
    buffer_load_dwordx4 v[148:151], v15, s[8:11], s6 offen nt
    s_add_u32 s6, s6, 7680
    buffer_load_dwordx4 v[152:155], v15, s[8:11], s6 offen nt
    s_add_u32 s6, s6, 7680
    buffer_load_dwordx4 v[156:159], v15, s[8:11], s6 offen nt
    s_add_u32 s6, s6, 7680
    buffer_load_dwordx4 v[160:163], v15, s[8:11], s6 offen nt
    s_add_u32 s6, s6, 7680
    buffer_load_dwordx4 v[164:167], v15, s[8:11], s6 offen nt
    s_add_u32 s6, s6, 7680
    buffer_load_dwordx4 v[168:171], v15, s[8:11], s6 offen nt
    s_add_u32 s6, s6, 7680
    buffer_load_dwordx4 v[172:175], v15, s[8:11], s6 offen nt
    s_add_u32 s6, s6, 7680
    buffer_load_dwordx4 v[176:179], v15, s[8:11], s6 offen nt
    s_add_u32 s6, s6, 7680
    buffer_load_dwordx4 v[180:183], v15, s[8:11], s6 offen nt
    s_add_u32 s6, s6, 7680
    buffer_load_dwordx4 v[184:187], v15, s[8:11], s6 offen nt
    s_add_u32 s6, s6, 7680
    buffer_load_dwordx4 v[188:191], v15, s[8:11], s6 offen nt
    s_cmp_eq_u32 s28, s3
    s_cbranch_scc0 L_ngo
L_ygo:
    s_mov_b64 exec, 1
    v_mov_b32 v36, 44
    v_mov_b32 v37, 1
    ds_add_u32 v36, v37
    s_mov_b64 exec, -1
L_ngo:
    s_waitcnt vmcnt(32)
    v_lshlrev_b32 v32, 16, v32
    v_lshlrev_b32 v33, 16, v33
    v_mul_f32 v34, 0xbfb8aa3b, v32
    v_mul_f32 v35, 0xbfb8aa3b, v33
    v_exp_f32 v34, v34
    v_exp_f32 v35, v35
    v_add_f32 v34, 1.0, v34
    v_add_f32 v35, 1.0, v35
    v_rcp_f32 v34, v34
    v_rcp_f32 v35, v35
    v_mul_f32 v32, v32, v34
    v_mul_f32 v33, v33, v35
    v_cvt_pk_bf16_f32 v12, v32, v32
    v_cvt_pk_bf16_f32 v13, v33, v33
    s_nop 0
    v_and_b32_dpp v20, v12, v6 row_newbcast:0 row_mask:0xf bank_mask:0xf
    v_and_b32_dpp v21, v12, v7 row_newbcast:0 row_mask:0xf bank_mask:0xf
    v_and_b32_dpp v22, v12, v8 row_newbcast:0 row_mask:0xf bank_mask:0xf
    v_and_b32_dpp v23, v12, v9 row_newbcast:0 row_mask:0xf bank_mask:0xf
    v_and_b32_dpp v24, v12, v6 row_newbcast:1 row_mask:0xf bank_mask:0xf
    v_and_b32_dpp v25, v12, v7 row_newbcast:1 row_mask:0xf bank_mask:0xf
    v_and_b32_dpp v26, v12, v8 row_newbcast:1 row_mask:0xf bank_mask:0xf
    v_and_b32_dpp v27, v12, v9 row_newbcast:1 row_mask:0xf bank_mask:0xf
    s_waitcnt vmcnt(30)
    v_mfma_f32_16x16x32_bf16 v[16:19], v[64:67], v[20:23], v[16:19]
    v_and_b32_dpp v20, v12, v6 row_newbcast:2 row_mask:0xf bank_mask:0xf
    v_and_b32_dpp v21, v12, v7 row_newbcast:2 row_mask:0xf bank_mask:0xf
    v_and_b32_dpp v22, v12, v8 row_newbcast:2 row_mask:0xf bank_mask:0xf
    v_and_b32_dpp v23, v12, v9 row_newbcast:2 row_mask:0xf bank_mask:0xf
    v_mfma_f32_16x16x32_bf16 v[16:19], v[68:71], v[24:27], v[16:19]
    v_and_b32_dpp v24, v12, v6 row_newbcast:3 row_mask:0xf bank_mask:0xf
    v_and_b32_dpp v25, v12, v7 row_newbcast:3 row_mask:0xf bank_mask:0xf
    v_and_b32_dpp v26, v12, v8 row_newbcast:3 row_mask:0xf bank_mask:0xf
    v_and_b32_dpp v27, v12, v9 row_newbcast:3 row_mask:0xf bank_mask:0xf
    s_waitcnt vmcnt(28)
    v_mfma_f32_16x16x32_bf16 v[16:19], v[72:75], v[20:23], v[16:19]
    v_and_b32_dpp v20, v12, v6 row_newbcast:4 row_mask:0xf bank_mask:0xf
    v_and_b32_dpp v21, v12, v7 row_newbcast:4 row_mask:0xf bank_mask:0xf
    v_and_b32_dpp v22, v12, v8 row_newbcast:4 row_mask:0xf bank_mask:0xf
    v_and_b32_dpp v23, v12, v9 row_newbcast:4 row_mask:0xf bank_mask:0xf
    v_mfma_f32_16x16x32_bf16 v[16:19], v[76:79], v[24:27], v[16:19]
    v_and_b32_dpp v24, v12, v6 row_newbcast:5 row_mask:0xf bank_mask:0xf
    v_and_b32_dpp v25, v12, v7 row_newbcast:5 row_mask:0xf bank_mask:0xf
    v_and_b32_dpp v26, v12, v8 row_newbcast:5 row_mask:0xf bank_mask:0xf
    v_and_b32_dpp v27, v12, v9 row_newbcast:5 row_mask:0xf bank_mask:0xf
    s_waitcnt vmcnt(26)
    v_mfma_f32_16x16x32_bf16 v[16:19], v[80:83], v[20:23], v[16:19]
    v_and_b32_dpp v20, v12, v6 row_newbcast:6 row_mask:0xf bank_mask:0xf
    v_and_b32_dpp v21, v12, v7 row_newbcast:6 row_mask:0xf bank_mask:0xf
    v_and_b32_dpp v22, v12, v8 row_newbcast:6 row_mask:0xf bank_mask:0xf
    v_and_b32_dpp v23, v12, v9 row_newbcast:6 row_mask:0xf bank_mask:0xf
    v_mfma_f32_16x16x32_bf16 v[16:19], v[84:87], v[24:27], v[16:19]
    v_and_b32_dpp v24, v12, v6 row_newbcast:7 row_mask:0xf bank_mask:0xf
    v_and_b32_dpp v25, v12, v7 row_newbcast:7 row_mask:0xf bank_mask:0xf
    v_and_b32_dpp v26, v12, v8 row_newbcast:7 row_mask:0xf bank_mask:0xf
    v_and_b32_dpp v27, v12, v9 row_newbcast:7 row_mask:0xf bank_mask:0xf
    s_waitcnt vmcnt(24)
    v_mfma_f32_16x16x32_bf16 v[16:19], v[88:91], v[20:23], v[16:19]
    v_and_b32_dpp v20, v12, v6 row_newbcast:8 row_mask:0xf bank_mask:0xf
    v_and_b32_dpp v21, v12, v7 row_newbcast:8 row_mask:0xf bank_mask:0xf
    v_and_b32_dpp v22, v12, v8 row_newbcast:8 row_mask:0xf bank_mask:0xf
    v_and_b32_dpp v23, v12, v9 row_newbcast:8 row_mask:0xf bank_mask:0xf
    v_mfma_f32_16x16x32_bf16 v[16:19], v[92:95], v[24:27], v[16:19]
    v_and_b32_dpp v24, v12, v6 row_newbcast:9 row_mask:0xf bank_mask:0xf
    v_and_b32_dpp v25, v12, v7 row_newbcast:9 row_mask:0xf bank_mask:0xf
    v_and_b32_dpp v26, v12, v8 row_newbcast:9 row_mask:0xf bank_mask:0xf
    v_and_b32_dpp v27, v12, v9 row_newbcast:9 row_mask:0xf bank_mask:0xf
    s_waitcnt vmcnt(22)
    v_mfma_f32_16x16x32_bf16 v[16:19], v[96:99], v[20:23], v[16:19]
    v_and_b32_dpp v20, v12, v6 row_newbcast:10 row_mask:0xf bank_mask:0xf
    v_and_b32_dpp v21, v12, v7 row_newbcast:10 row_mask:0xf bank_mask:0xf
    v_and_b32_dpp v22, v12, v8 row_newbcast:10 row_mask:0xf bank_mask:0xf
    v_and_b32_dpp v23, v12, v9 row_newbcast:10 row_mask:0xf bank_mask:0xf
    v_mfma_f32_16x16x32_bf16 v[16:19], v[100:103], v[24:27], v[16:19]
    v_and_b32_dpp v24, v12, v6 row_newbcast:11 row_mask:0xf bank_mask:0xf
    v_and_b32_dpp v25, v12, v7 row_newbcast:11 row_mask:0xf bank_mask:0xf
    v_and_b32_dpp v26, v12, v8 row_newbcast:11 row_mask:0xf bank_mask:0xf
    v_and_b32_dpp v27, v12, v9 row_newbcast:11 row_mask:0xf bank_mask:0xf
    s_waitcnt vmcnt(20)
    v_mfma_f32_16x16x32_bf16 v[16:19], v[104:107], v[20:23], v[16:19]
    v_and_b32_dpp v20, v12, v6 row_newbcast:12 row_mask:0xf bank_mask:0xf
    v_and_b32_dpp v21, v12, v7 row_newbcast:12 row_mask:0xf bank_mask:0xf
    v_and_b32_dpp v22, v12, v8 row_newbcast:12 row_mask:0xf bank_mask:0xf
    v_and_b32_dpp v23, v12, v9 row_newbcast:12 row_mask:0xf bank_mask:0xf
    v_mfma_f32_16x16x32_bf16 v[16:19], v[108:111], v[24:27], v[16:19]
    v_and_b32_dpp v24, v12, v6 row_newbcast:13 row_mask:0xf bank_mask:0xf
    v_and_b32_dpp v25, v12, v7 row_newbcast:13 row_mask:0xf bank_mask:0xf
    v_and_b32_dpp v26, v12, v8 row_newbcast:13 row_mask:0xf bank_mask:0xf
    v_and_b32_dpp v27, v12, v9 row_newbcast:13 row_mask:0xf bank_mask:0xf
    s_waitcnt vmcnt(18)
    v_mfma_f32_16x16x32_bf16 v[16:19], v[112:115], v[20:23], v[16:19]
    v_and_b32_dpp v20, v12, v6 row_newbcast:14 row_mask:0xf bank_mask:0xf
    v_and_b32_dpp v21, v12, v7 row_newbcast:14 row_mask:0xf bank_mask:0xf
    v_and_b32_dpp v22, v12, v8 row_newbcast:14 row_mask:0xf bank_mask:0xf
    v_and_b32_dpp v23, v12, v9 row_newbcast:14 row_mask:0xf bank_mask:0xf
    v_mfma_f32_16x16x32_bf16 v[16:19], v[116:119], v[24:27], v[16:19]
    v_and_b32_dpp v24, v12, v6 row_newbcast:15 row_mask:0xf bank_mask:0xf
    v_and_b32_dpp v25, v12, v7 row_newbcast:15 row_mask:0xf bank_mask:0xf
    v_and_b32_dpp v26, v12, v8 row_newbcast:15 row_mask:0xf bank_mask:0xf
    v_and_b32_dpp v27, v12, v9 row_newbcast:15 row_mask:0xf bank_mask:0xf
    s_waitcnt vmcnt(16)
    v_mfma_f32_16x16x32_bf16 v[16:19], v[120:123], v[20:23], v[16:19]
    v_and_b32_dpp v20, v13, v6 row_newbcast:0 row_mask:0xf bank_mask:0xf
    v_and_b32_dpp v21, v13, v7 row_newbcast:0 row_mask:0xf bank_mask:0xf
    v_and_b32_dpp v22, v13, v8 row_newbcast:0 row_mask:0xf bank_mask:0xf
    v_and_b32_dpp v23, v13, v9 row_newbcast:0 row_mask:0xf bank_mask:0xf
    v_mfma_f32_16x16x32_bf16 v[16:19], v[124:127], v[24:27], v[16:19]
    v_and_b32_dpp v24, v13, v6 row_newbcast:1 row_mask:0xf bank_mask:0xf
    v_and_b32_dpp v25, v13, v7 row_newbcast:1 row_mask:0xf bank_mask:0xf
    v_and_b32_dpp v26, v13, v8 row_newbcast:1 row_mask:0xf bank_mask:0xf
    v_and_b32_dpp v27, v13, v9 row_newbcast:1 row_mask:0xf bank_mask:0xf
    s_waitcnt vmcnt(14)
    v_mfma_f32_16x16x32_bf16 v[16:19], v[128:131], v[20:23], v[16:19]
    v_and_b32_dpp v20, v13, v6 row_newbcast:2 row_mask:0xf bank_mask:0xf
    v_and_b32_dpp v21, v13, v7 row_newbcast:2 row_mask:0xf bank_mask:0xf
    v_and_b32_dpp v22, v13, v8 row_newbcast:2 row_mask:0xf bank_mask:0xf
    v_and_b32_dpp v23, v13, v9 row_newbcast:2 row_mask:0xf bank_mask:0xf
    v_mfma_f32_16x16x32_bf16 v[16:19], v[132:135], v[24:27], v[16:19]
    v_and_b32_dpp v24, v13, v6 row_newbcast:3 row_mask:0xf bank_mask:0xf
    v_and_b32_dpp v25, v13, v7 row_newbcast:3 row_mask:0xf bank_mask:0xf
    v_and_b32_dpp v26, v13, v8 row_newbcast:3 row_mask:0xf bank_mask:0xf
    v_and_b32_dpp v27, v13, v9 row_newbcast:3 row_mask:0xf bank_mask:0xf
    s_waitcnt vmcnt(12)
    v_mfma_f32_16x16x32_bf16 v[16:19], v[136:139], v[20:23], v[16:19]
    v_and_b32_dpp v20, v13, v6 row_newbcast:4 row_mask:0xf bank_mask:0xf
    v_and_b32_dpp v21, v13, v7 row_newbcast:4 row_mask:0xf bank_mask:0xf
    v_and_b32_dpp v22, v13, v8 row_newbcast:4 row_mask:0xf bank_mask:0xf
    v_and_b32_dpp v23, v13, v9 row_newbcast:4 row_mask:0xf bank_mask:0xf
    v_mfma_f32_16x16x32_bf16 v[16:19], v[140:143], v[24:27], v[16:19]
    v_and_b32_dpp v24, v13, v6 row_newbcast:5 row_mask:0xf bank_mask:0xf
    v_and_b32_dpp v25, v13, v7 row_newbcast:5 row_mask:0xf bank_mask:0xf
    v_and_b32_dpp v26, v13, v8 row_newbcast:5 row_mask:0xf bank_mask:0xf
    v_and_b32_dpp v27, v13, v9 row_newbcast:5 row_mask:0xf bank_mask:0xf
    s_waitcnt vmcnt(10)
    v_mfma_f32_16x16x32_bf16 v[16:19], v[144:147], v[20:23], v[16:19]
    v_and_b32_dpp v20, v13, v6 row_newbcast:6 row_mask:0xf bank_mask:0xf
    v_and_b32_dpp v21, v13, v7 row_newbcast:6 row_mask:0xf bank_mask:0xf
    v_and_b32_dpp v22, v13, v8 row_newbcast:6 row_mask:0xf bank_mask:0xf
    v_and_b32_dpp v23, v13, v9 row_newbcast:6 row_mask:0xf bank_mask:0xf
    v_mfma_f32_16x16x32_bf16 v[16:19], v[148:151], v[24:27], v[16:19]
    v_and_b32_dpp v24, v13, v6 row_newbcast:7 row_mask:0xf bank_mask:0xf
    v_and_b32_dpp v25, v13, v7 row_newbcast:7 row_mask:0xf bank_mask:0xf
    v_and_b32_dpp v26, v13, v8 row_newbcast:7 row_mask:0xf bank_mask:0xf
    v_and_b32_dpp v27, v13, v9 row_newbcast:7 row_mask:0xf bank_mask:0xf
    s_waitcnt vmcnt(8)
    v_mfma_f32_16x16x32_bf16 v[16:19], v[152:155], v[20:23], v[16:19]
    v_and_b32_dpp v20, v13, v6 row_newbcast:8 row_mask:0xf bank_mask:0xf
    v_and_b32_dpp v21, v13, v7 row_newbcast:8 row_mask:0xf bank_mask:0xf
    v_and_b32_dpp v22, v13, v8 row_newbcast:8 row_mask:0xf bank_mask:0xf
    v_and_b32_dpp v23, v13, v9 row_newbcast:8 row_mask:0xf bank_mask:0xf
    v_mfma_f32_16x16x32_bf16 v[16:19], v[156:159], v[24:27], v[16:19]
    v_and_b32_dpp v24, v13, v6 row_newbcast:9 row_mask:0xf bank_mask:0xf
    v_and_b32_dpp v25, v13, v7 row_newbcast:9 row_mask:0xf bank_mask:0xf
    v_and_b32_dpp v26, v13, v8 row_newbcast:9 row_mask:0xf bank_mask:0xf
    v_and_b32_dpp v27, v13, v9 row_newbcast:9 row_mask:0xf bank_mask:0xf
    s_waitcnt vmcnt(6)
    v_mfma_f32_16x16x32_bf16 v[16:19], v[160:163], v[20:23], v[16:19]
    v_and_b32_dpp v20, v13, v6 row_newbcast:10 row_mask:0xf bank_mask:0xf
    v_and_b32_dpp v21, v13, v7 row_newbcast:10 row_mask:0xf bank_mask:0xf
    v_and_b32_dpp v22, v13, v8 row_newbcast:10 row_mask:0xf bank_mask:0xf
    v_and_b32_dpp v23, v13, v9 row_newbcast:10 row_mask:0xf bank_mask:0xf
    v_mfma_f32_16x16x32_bf16 v[16:19], v[164:167], v[24:27], v[16:19]
    v_and_b32_dpp v24, v13, v6 row_newbcast:11 row_mask:0xf bank_mask:0xf
    v_and_b32_dpp v25, v13, v7 row_newbcast:11 row_mask:0xf bank_mask:0xf
    v_and_b32_dpp v26, v13, v8 row_newbcast:11 row_mask:0xf bank_mask:0xf
    v_and_b32_dpp v27, v13, v9 row_newbcast:11 row_mask:0xf bank_mask:0xf
    s_waitcnt vmcnt(4)
    v_mfma_f32_16x16x32_bf16 v[16:19], v[168:171], v[20:23], v[16:19]
    v_and_b32_dpp v20, v13, v6 row_newbcast:12 row_mask:0xf bank_mask:0xf
    v_and_b32_dpp v21, v13, v7 row_newbcast:12 row_mask:0xf bank_mask:0xf
    v_and_b32_dpp v22, v13, v8 row_newbcast:12 row_mask:0xf bank_mask:0xf
    v_and_b32_dpp v23, v13, v9 row_newbcast:12 row_mask:0xf bank_mask:0xf
    v_mfma_f32_16x16x32_bf16 v[16:19], v[172:175], v[24:27], v[16:19]
    v_and_b32_dpp v24, v13, v6 row_newbcast:13 row_mask:0xf bank_mask:0xf
    v_and_b32_dpp v25, v13, v7 row_newbcast:13 row_mask:0xf bank_mask:0xf
    v_and_b32_dpp v26, v13, v8 row_newbcast:13 row_mask:0xf bank_mask:0xf
    v_and_b32_dpp v27, v13, v9 row_newbcast:13 row_mask:0xf bank_mask:0xf
    s_waitcnt vmcnt(2)
    v_mfma_f32_16x16x32_bf16 v[16:19], v[176:179], v[20:23], v[16:19]
    v_and_b32_dpp v20, v13, v6 row_newbcast:14 row_mask:0xf bank_mask:0xf
    v_and_b32_dpp v21, v13, v7 row_newbcast:14 row_mask:0xf bank_mask:0xf
    v_and_b32_dpp v22, v13, v8 row_newbcast:14 row_mask:0xf bank_mask:0xf
    v_and_b32_dpp v23, v13, v9 row_newbcast:14 row_mask:0xf bank_mask:0xf
    v_mfma_f32_16x16x32_bf16 v[16:19], v[180:183], v[24:27], v[16:19]
    v_and_b32_dpp v24, v13, v6 row_newbcast:15 row_mask:0xf bank_mask:0xf
    v_and_b32_dpp v25, v13, v7 row_newbcast:15 row_mask:0xf bank_mask:0xf
    v_and_b32_dpp v26, v13, v8 row_newbcast:15 row_mask:0xf bank_mask:0xf
    v_and_b32_dpp v27, v13, v9 row_newbcast:15 row_mask:0xf bank_mask:0xf
    s_waitcnt vmcnt(0)
    v_mfma_f32_16x16x32_bf16 v[16:19], v[184:187], v[20:23], v[16:19]
    v_mfma_f32_16x16x32_bf16 v[16:19], v[188:191], v[24:27], v[16:19]
    s_add_u32 s24, s24, 983040
    s_add_u32 s27, s27, 256
    s_sub_u32 s28, s28, 1
    s_cmp_lg_u32 s28, 0
    s_cbranch_scc1 L_aml
    s_waitcnt lgkmcnt(0)
    s_mul_i32 s64, s64, 1664525
    s_add_u32 s64, s64, 1013904223
    s_movk_i32 s69, 0xff
    s_mov_b32 s25, s33
    s_call_b64 s[30:31], L_pub
    s_cmp_eq_u32 s3, 0
    s_cbranch_scc1 L_q2
    s_branch L_tail
L_m0:
    s_cmp_ge_u32 s4, 15
    s_cbranch_scc1 L_t0
    s_cmp_eq_u32 s5, 7
    s_cbranch_scc1 L_t0
    s_lshl_b32 s6, s4, 1
    s_add_u32 s6, s6, s5
    s_sub_u32 s6, s6, 5
    s_cmp_lt_u32 s4, 5
    s_cbranch_scc1 L_m1
    s_cmp_eq_u32 s5, 6
    s_cbranch_scc1 L_t0
    s_add_u32 s6, s4, 5
L_m1:
    s_lshl_b32 s24, s6, 8
    s_add_u32 s24, s24, 2560
    s_mov_b32 s27, 0
    s_mov_b32 s28, 5
    s_movk_i32 s29, 128
    s_lshl_b32 s33, s6, 10
    s_add_u32 s33, s33, 294912
    s_mov_b32 s35, 880281
    v_mov_b32 v32, 52
Lw_3:
    s_sub_u32 s35, s35, 1
    s_cbranch_scc1 Lx_4
    ds_read_b32 v33, v32
    s_waitcnt lgkmcnt(0)
    v_readfirstlane_b32 s34, v33
    s_nop 0
    s_cmp_ge_u32 s34, 1
    s_cbranch_scc1 Lx_4
    s_sleep 8
    s_branch Lw_3
Lx_4:
    s_branch L_am
L_pub:
    v_and_b32 v35, 1, v3
    v_lshlrev_b32 v35, 5, v35
    v_lshrrev_b32 v36, 3, v2
    v_lshl_add_u32 v35, v36, 4, v35
    v_and_b32 v36, 7, v2
    v_add_u32 v35, v35, v36
    v_lshrrev_b32 v36, 1, v3
    v_lshl_add_u32 v35, v36, 3, v35
    v_lshlrev_b32 v35, 4, v35
    v_mov_b32_dpp v16, v18 row_shr:8 row_mask:0xf bank_mask:0xc
    v_mov_b32_dpp v17, v19 row_shr:8 row_mask:0xf bank_mask:0xc
    s_cmp_lt_u32 s5, 5
    s_cbranch_scc0 L_pubm
    v_lshrrev_b32 v35, 1, v35
    v_permlane32_swap_b32 v16, v17
    v_lshrrev_b32 v36, 4, v35
    v_add_u32 v36, s64, v36
    v_bfi_b32 v16, 15, v36, v16
    v_bfi_b32 v17, 15, v36, v17
    buffer_store_dwordx2 v[16:17], v35, s[16:19], s25 offen sc1
    s_setpc_b64 s[30:31]
L_pubm:
    v_mov_b32 v19, s64
    v_mov_b32 v18, v17
    v_mov_b32 v17, s64
    s_nop 0
    v_permlane32_swap_b32 v16, v18
    buffer_store_dwordx4 v[16:19], v35, s[16:19], s25 offen sc1
    s_setpc_b64 s[30:31]
L_stB:
    s_cmp_eq_u32 s3, 0
    s_cbranch_scc0 L_t0
    s_mov_b32 s8, s42
    s_mov_b32 s9, s43
    s_mov_b32 s10, 5242880
    s_mov_b32 s11, 0x20000
    s_mov_b32 s12, s36
    s_mov_b32 s13, s37
    s_mov_b32 s14, 1280
    s_mov_b32 s15, 0x20000
    v_lshlrev_b32 v13, 2, v1
    buffer_load_dword v32, v13, s[12:15], 0 offen offset:0
    buffer_load_dword v33, v13, s[12:15], 0 offen offset:256
    buffer_load_dword v34, v13, s[12:15], 0 offen offset:512
    buffer_load_dword v35, v13, s[12:15], 0 offen offset:768
    buffer_load_dword v36, v13, s[12:15], 0 offen offset:1024
    s_lshl_b32 s6, s5, 8
    buffer_load_ushort v52, v14, s[12:15], s6 offen
    buffer_load_ushort v53, v14, s[12:15], s6 offen offset:128
    v_lshlrev_b32 v15, 4, v2
    v_lshl_add_u32 v15, v3, 17, v15
    s_lshl_b32 s6, s5, 20
    s_lshl_b32 s7, s4, 8
    s_add_u32 s6, s6, s7
    buffer_load_dwordx4 v[64:67], v15, s[8:11], s6 offen nt
    s_add_u32 s6, s6, 8192
    buffer_load_dwordx4 v[68:71], v15, s[8:11], s6 offen nt
    s_add_u32 s6, s6, 8192
    buffer_load_dwordx4 v[72:75], v15, s[8:11], s6 offen nt
    s_add_u32 s6, s6, 8192
    buffer_load_dwordx4 v[76:79], v15, s[8:11], s6 offen nt
    s_add_u32 s6, s6, 8192
    buffer_load_dwordx4 v[80:83], v15, s[8:11], s6 offen nt
    s_add_u32 s6, s6, 8192
    buffer_load_dwordx4 v[84:87], v15, s[8:11], s6 offen nt
    s_add_u32 s6, s6, 8192
    buffer_load_dwordx4 v[88:91], v15, s[8:11], s6 offen nt
    s_add_u32 s6, s6, 8192
    buffer_load_dwordx4 v[92:95], v15, s[8:11], s6 offen nt
    s_add_u32 s6, s6, 8192
    buffer_load_dwordx4 v[96:99], v15, s[8:11], s6 offen nt
    s_add_u32 s6, s6, 8192
    buffer_load_dwordx4 v[100:103], v15, s[8:11], s6 offen nt
    s_add_u32 s6, s6, 8192
    buffer_load_dwordx4 v[104:107], v15, s[8:11], s6 offen nt
    s_add_u32 s6, s6, 8192
    buffer_load_dwordx4 v[108:111], v15, s[8:11], s6 offen nt
    s_add_u32 s6, s6, 8192
    buffer_load_dwordx4 v[112:115], v15, s[8:11], s6 offen nt
    s_add_u32 s6, s6, 8192
    buffer_load_dwordx4 v[116:119], v15, s[8:11], s6 offen nt
    s_add_u32 s6, s6, 8192
    buffer_load_dwordx4 v[120:123], v15, s[8:11], s6 offen nt
    s_add_u32 s6, s6, 8192
    buffer_load_dwordx4 v[124:127], v15, s[8:11], s6 offen nt
    s_add_u32 s6, s6, 401408
    buffer_load_dwordx4 v[128:131], v15, s[8:11], s6 offen nt
    s_add_u32 s6, s6, 8192
    buffer_load_dwordx4 v[132:135], v15, s[8:11], s6 offen nt
    s_add_u32 s6, s6, 8192
    buffer_load_dwordx4 v[136:139], v15, s[8:11], s6 offen nt
    s_add_u32 s6, s6, 8192
    buffer_load_dwordx4 v[140:143], v15, s[8:11], s6 offen nt
    s_add_u32 s6, s6, 8192
    buffer_load_dwordx4 v[144:147], v15, s[8:11], s6 offen nt
    s_add_u32 s6, s6, 8192
    buffer_load_dwordx4 v[148:151], v15, s[8:11], s6 offen nt
    s_add_u32 s6, s6, 8192
    buffer_load_dwordx4 v[152:155], v15, s[8:11], s6 offen nt
    s_add_u32 s6, s6, 8192
    buffer_load_dwordx4 v[156:159], v15, s[8:11], s6 offen nt
    s_add_u32 s6, s6, 8192
    buffer_load_dwordx4 v[160:163], v15, s[8:11], s6 offen nt
    s_add_u32 s6, s6, 8192
    buffer_load_dwordx4 v[164:167], v15, s[8:11], s6 offen nt
    s_add_u32 s6, s6, 8192
    buffer_load_dwordx4 v[168:171], v15, s[8:11], s6 offen nt
    s_add_u32 s6, s6, 8192
    buffer_load_dwordx4 v[172:175], v15, s[8:11], s6 offen nt
    s_add_u32 s6, s6, 8192
    buffer_load_dwordx4 v[176:179], v15, s[8:11], s6 offen nt
    s_add_u32 s6, s6, 8192
    buffer_load_dwordx4 v[180:183], v15, s[8:11], s6 offen nt
    s_add_u32 s6, s6, 8192
    buffer_load_dwordx4 v[184:187], v15, s[8:11], s6 offen nt
    s_add_u32 s6, s6, 8192
    buffer_load_dwordx4 v[188:191], v15, s[8:11], s6 offen nt
    s_waitcnt vmcnt(32)
    s_cmp_eq_u32 s5, 0
    s_cbranch_scc0 L_ntk
    s_mul_i32 s6, s4, 4352
    s_add_u32 s6, s6, 1048576
    v_mov_b32 v18, 0
    s_mov_b64 exec, 1
    buffer_store_dword v18, v18, s[16:19], s6 offen sc1
    s_mov_b64 exec, -1
L_ntk:
    v_lshlrev_b32 v40, 16, v32
    v_and_b32 v41, 0xffff0000, v32
    v_lshlrev_b32 v42, 16, v33
    v_and_b32 v43, 0xffff0000, v33
    v_lshlrev_b32 v44, 16, v34
    v_and_b32 v45, 0xffff0000, v34
    v_lshlrev_b32 v46, 16, v35
    v_and_b32 v47, 0xffff0000, v35
    v_lshlrev_b32 v48, 16, v36
    v_and_b32 v49, 0xffff0000, v36
    v_add_f32 v38, v40, v41
    v_add_f32 v38, v38, v42
    v_add_f32 v38, v38, v43
    v_add_f32 v38, v38, v44
    v_add_f32 v38, v38, v45
    v_add_f32 v38, v38, v46
    v_add_f32 v38, v38, v47
    v_add_f32 v38, v38, v48
    v_add_f32 v38, v38, v49
    s_nop 1
    v_add_f32_dpp v38, v38, v38 row_ror:8 row_mask:0xf bank_mask:0xf
    s_nop 1
    v_add_f32_dpp v38, v38, v38 row_ror:4 row_mask:0xf bank_mask:0xf
    s_nop 1
    v_add_f32_dpp v38, v38, v38 row_ror:2 row_mask:0xf bank_mask:0xf
    s_nop 1
    v_add_f32_dpp v38, v38, v38 row_ror:1 row_mask:0xf bank_mask:0xf
    v_mov_b32 v39, v38
    s_nop 1
    v_permlane16_swap_b32 v38, v39
    v_add_f32 v38, v38, v39
    v_mov_b32 v39, v38
    s_nop 1
    v_permlane32_swap_b32 v38, v39
    v_add_f32 v38, v38, v39
    v_mul_f32 v38, 0x3acccccd, v38
    v_sub_f32 v40, v40, v38
    v_sub_f32 v41, v41, v38
    v_sub_f32 v42, v42, v38
    v_sub_f32 v43, v43, v38
    v_sub_f32 v44, v44, v38
    v_sub_f32 v45, v45, v38
    v_sub_f32 v46, v46, v38
    v_sub_f32 v47, v47, v38
    v_sub_f32 v48, v48, v38
    v_sub_f32 v49, v49, v38
    v_mul_f32 v50, v40, v40
    v_fmac_f32 v50, v41, v41
    v_fmac_f32 v50, v42, v42
    v_fmac_f32 v50, v43, v43
    v_fmac_f32 v50, v44, v44
    v_fmac_f32 v50, v45, v45
    v_fmac_f32 v50, v46, v46
    v_fmac_f32 v50, v47, v47
    v_fmac_f32 v50, v48, v48
    v_fmac_f32 v50, v49, v49
    s_nop 1
    v_add_f32_dpp v50, v50, v50 row_ror:8 row_mask:0xf bank_mask:0xf
    s_nop 1
    v_add_f32_dpp v50, v50, v50 row_ror:4 row_mask:0xf bank_mask:0xf
    s_nop 1
    v_add_f32_dpp v50, v50, v50 row_ror:2 row_mask:0xf bank_mask:0xf
    s_nop 1
    v_add_f32_dpp v50, v50, v50 row_ror:1 row_mask:0xf bank_mask:0xf
    v_mov_b32 v39, v50
    s_nop 1
    v_permlane16_swap_b32 v50, v39
    v_add_f32 v50, v50, v39
    v_mov_b32 v39, v50
    s_nop 1
    v_permlane32_swap_b32 v50, v39
    v_add_f32 v50, v50, v39
    v_mul_f32 v50, 0x3acccccd, v50
    v_cvt_pk_bf16_f32 v38, v38, v38
    v_and_b32 v38, 0xffff0000, v38
    v_cvt_pk_bf16_f32 v50, v50, v50
    v_and_b32 v50, 0xffff0000, v50
    v_add_f32 v50, 0x3727c5ac, v50
    v_cvt_pk_bf16_f32 v50, v50, v50
    v_and_b32 v50, 0xffff0000, v50
    v_sqrt_f32 v50, v50
    s_nop 0
    v_cvt_pk_bf16_f32 v50, v50, v50
    v_and_b32 v50, 0xffff0000, v50
    v_rcp_f32 v50, v50
    v_lshlrev_b32 v52, 16, v52
    v_lshlrev_b32 v53, 16, v53
    v_sub_f32 v52, v52, v38
    v_sub_f32 v53, v53, v38
    v_cvt_pk_bf16_f32 v53, v52, v53
    v_lshlrev_b32 v52, 16, v53
    v_and_b32 v53, 0xffff0000, v53
    v_mul_f32 v52, v52, v50
    v_mul_f32 v53, v53, v50
    v_cvt_pk_bf16_f32 v53, v52, v53
    v_lshlrev_b32 v52, 16, v53
    v_and_b32 v53, 0xffff0000, v53
    v_mov_b32 v16, 0
    v_mov_b32 v17, 0
    v_mov_b32 v18, 0
    v_mov_b32 v19, 0
    s_waitcnt lgkmcnt(0)
    s_mul_i32 s64, s64, 1664525
    s_add_u32 s64, s64, 1013904223
    s_movk_i32 s69, 0xff
    s_mul_i32 s24, s5, 10240
    s_add_u32 s24, s24, 65536
    s_call_b64 s[84:85], L_plan
    s_sleep 50
    s_add_u32 s25, s24, 4096
    s_add_u32 s26, s24, 8192
    s_mov_b32 s35, 2000000
L_gh_l:
    buffer_load_dwordx4 v[192:195], v11, s[16:19], s24 offen offset:0 sc1
    buffer_load_dwordx4 v[196:199], v11, s[16:19], s24 offen offset:1024 sc1
    buffer_load_dwordx4 v[200:203], v11, s[16:19], s24 offen offset:2048 sc1
    buffer_load_dwordx4 v[204:207], v11, s[16:19], s24 offen offset:3072 sc1
    buffer_load_dwordx4 v[208:211], v11, s[16:19], s25 offen offset:0 sc1
    buffer_load_dwordx4 v[212:215], v11, s[16:19], s25 offen offset:1024 sc1
    buffer_load_dwordx4 v[216:219], v11, s[16:19], s25 offen offset:2048 sc1
    buffer_load_dwordx4 v[220:223], v11, s[16:19], s25 offen offset:3072 sc1
    buffer_load_dwordx4 v[224:227], v11, s[16:19], s26 offen offset:0 sc1
    buffer_load_dwordx4 v[228:231], v11, s[16:19], s26 offen offset:1024 sc1
    v_mov_b32 v34, 0
    s_waitcnt vmcnt(9)
    v_bitop3_b32 v34, v193, s64, v34 bitop3:0xbe
    v_bitop3_b32 v34, v195, s64, v34 bitop3:0xbe
    s_waitcnt vmcnt(8)
    v_bitop3_b32 v34, v197, s64, v34 bitop3:0xbe
    v_bitop3_b32 v34, v199, s64, v34 bitop3:0xbe
    v_add_f32 v40, v192, v196
    v_add_f32 v41, v194, v198
    s_waitcnt vmcnt(7)
    v_bitop3_b32 v34, v201, s64, v34 bitop3:0xbe
    v_bitop3_b32 v34, v203, s64, v34 bitop3:0xbe
    v_add_f32 v40, v40, v200
    v_add_f32 v41, v41, v202
    s_waitcnt vmcnt(6)
    v_bitop3_b32 v34, v205, s64, v34 bitop3:0xbe
    v_bitop3_b32 v34, v207, s64, v34 bitop3:0xbe
    v_add_f32 v40, v40, v204
    v_add_f32 v41, v41, v206
    s_waitcnt vmcnt(5)
    v_bitop3_b32 v34, v209, s64, v34 bitop3:0xbe
    v_bitop3_b32 v34, v211, s64, v34 bitop3:0xbe
    v_add_f32 v40, v40, v208
    v_add_f32 v41, v41, v210
    s_waitcnt vmcnt(4)
    v_bitop3_b32 v34, v213, s64, v34 bitop3:0xbe
    v_bitop3_b32 v34, v215, s64, v34 bitop3:0xbe
    s_waitcnt vmcnt(3)
    v_bitop3_b32 v34, v217, s64, v34 bitop3:0xbe
    v_bitop3_b32 v34, v219, s64, v34 bitop3:0xbe
    v_add_f32 v42, v212, v216
    v_add_f32 v43, v214, v218
    s_waitcnt vmcnt(2)
    v_bitop3_b32 v34, v221, s64, v34 bitop3:0xbe
    v_bitop3_b32 v34, v223, s64, v34 bitop3:0xbe
    v_add_f32 v42, v42, v220
    v_add_f32 v43, v43, v222
    s_waitcnt vmcnt(1)
    v_bitop3_b32 v34, v225, s64, v34 bitop3:0xbe
    v_bitop3_b32 v34, v227, s64, v34 bitop3:0xbe
    v_add_f32 v42, v42, v224
    v_add_f32 v43, v43, v226
    s_waitcnt vmcnt(0)
    v_bitop3_b32 v34, v229, s64, v34 bitop3:0xbe
    v_bitop3_b32 v34, v231, s64, v34 bitop3:0xbe
    v_add_f32 v42, v42, v228
    v_add_f32 v43, v43, v230
    v_cmp_ne_u32 vcc, 0, v34
    s_cbranch_vccz L_gh_x
    s_sub_u32 s35, s35, 1
    s_cbranch_scc1 L_gh_x
    s_sleep 8
    s_branch L_gh_l
L_gh_x:
    v_cvt_pk_bf16_f32 v41, v40, v41
    v_cvt_pk_bf16_f32 v43, v42, v43
    v_lshlrev_b32 v40, 16, v41
    v_lshlrev_b32 v42, 16, v43
    v_and_b32 v41, 0xffff0000, v41
    v_and_b32 v43, 0xffff0000, v43
    v_add_f32 v44, 1.0, v41
    v_add_f32 v45, 1.0, v43
    v_cvt_pk_bf16_f32 v45, v44, v45
    v_lshlrev_b32 v44, 16, v45
    v_and_b32 v45, 0xffff0000, v45
    v_pk_mul_f32 v[44:45], v[44:45], v[52:53]
    v_cvt_pk_bf16_f32 v45, v44, v45
    v_lshlrev_b32 v44, 16, v45
    v_and_b32 v45, 0xffff0000, v45
    v_add_f32 v44, v44, v40
    v_add_f32 v45, v45, v42
    v_cvt_pk_bf16_f32 v12, v44, v44
    v_cvt_pk_bf16_f32 v13, v45, v45
    s_nop 0
    v_and_b32_dpp v20, v12, v6 row_newbcast:0 row_mask:0xf bank_mask:0xf
    v_and_b32_dpp v21, v12, v7 row_newbcast:0 row_mask:0xf bank_mask:0xf
    v_and_b32_dpp v22, v12, v8 row_newbcast:0 row_mask:0xf bank_mask:0xf
    v_and_b32_dpp v23, v12, v9 row_newbcast:0 row_mask:0xf bank_mask:0xf
    v_and_b32_dpp v24, v12, v6 row_newbcast:1 row_mask:0xf bank_mask:0xf
    v_and_b32_dpp v25, v12, v7 row_newbcast:1 row_mask:0xf bank_mask:0xf
    v_and_b32_dpp v26, v12, v8 row_newbcast:1 row_mask:0xf bank_mask:0xf
    v_and_b32_dpp v27, v12, v9 row_newbcast:1 row_mask:0xf bank_mask:0xf
    v_mfma_f32_16x16x32_bf16 v[16:19], v[64:67], v[20:23], v[16:19]
    v_and_b32_dpp v20, v12, v6 row_newbcast:2 row_mask:0xf bank_mask:0xf
    v_and_b32_dpp v21, v12, v7 row_newbcast:2 row_mask:0xf bank_mask:0xf
    v_and_b32_dpp v22, v12, v8 row_newbcast:2 row_mask:0xf bank_mask:0xf
    v_and_b32_dpp v23, v12, v9 row_newbcast:2 row_mask:0xf bank_mask:0xf
    v_mfma_f32_16x16x32_bf16 v[16:19], v[68:71], v[24:27], v[16:19]
    v_and_b32_dpp v24, v12, v6 row_newbcast:3 row_mask:0xf bank_mask:0xf
    v_and_b32_dpp v25, v12, v7 row_newbcast:3 row_mask:0xf bank_mask:0xf
    v_and_b32_dpp v26, v12, v8 row_newbcast:3 row_mask:0xf bank_mask:0xf
    v_and_b32_dpp v27, v12, v9 row_newbcast:3 row_mask:0xf bank_mask:0xf
    v_mfma_f32_16x16x32_bf16 v[16:19], v[72:75], v[20:23], v[16:19]
    v_and_b32_dpp v20, v12, v6 row_newbcast:4 row_mask:0xf bank_mask:0xf
    v_and_b32_dpp v21, v12, v7 row_newbcast:4 row_mask:0xf bank_mask:0xf
    v_and_b32_dpp v22, v12, v8 row_newbcast:4 row_mask:0xf bank_mask:0xf
    v_and_b32_dpp v23, v12, v9 row_newbcast:4 row_mask:0xf bank_mask:0xf
    v_mfma_f32_16x16x32_bf16 v[16:19], v[76:79], v[24:27], v[16:19]
    v_and_b32_dpp v24, v12, v6 row_newbcast:5 row_mask:0xf bank_mask:0xf
    v_and_b32_dpp v25, v12, v7 row_newbcast:5 row_mask:0xf bank_mask:0xf
    v_and_b32_dpp v26, v12, v8 row_newbcast:5 row_mask:0xf bank_mask:0xf
    v_and_b32_dpp v27, v12, v9 row_newbcast:5 row_mask:0xf bank_mask:0xf
    v_mfma_f32_16x16x32_bf16 v[16:19], v[80:83], v[20:23], v[16:19]
    v_and_b32_dpp v20, v12, v6 row_newbcast:6 row_mask:0xf bank_mask:0xf
    v_and_b32_dpp v21, v12, v7 row_newbcast:6 row_mask:0xf bank_mask:0xf
    v_and_b32_dpp v22, v12, v8 row_newbcast:6 row_mask:0xf bank_mask:0xf
    v_and_b32_dpp v23, v12, v9 row_newbcast:6 row_mask:0xf bank_mask:0xf
    v_mfma_f32_16x16x32_bf16 v[16:19], v[84:87], v[24:27], v[16:19]
    v_and_b32_dpp v24, v12, v6 row_newbcast:7 row_mask:0xf bank_mask:0xf
    v_and_b32_dpp v25, v12, v7 row_newbcast:7 row_mask:0xf bank_mask:0xf
    v_and_b32_dpp v26, v12, v8 row_newbcast:7 row_mask:0xf bank_mask:0xf
    v_and_b32_dpp v27, v12, v9 row_newbcast:7 row_mask:0xf bank_mask:0xf
    v_mfma_f32_16x16x32_bf16 v[16:19], v[88:91], v[20:23], v[16:19]
    v_and_b32_dpp v20, v12, v6 row_newbcast:8 row_mask:0xf bank_mask:0xf
    v_and_b32_dpp v21, v12, v7 row_newbcast:8 row_mask:0xf bank_mask:0xf
    v_and_b32_dpp v22, v12, v8 row_newbcast:8 row_mask:0xf bank_mask:0xf
    v_and_b32_dpp v23, v12, v9 row_newbcast:8 row_mask:0xf bank_mask:0xf
    v_mfma_f32_16x16x32_bf16 v[16:19], v[92:95], v[24:27], v[16:19]
    v_and_b32_dpp v24, v12, v6 row_newbcast:9 row_mask:0xf bank_mask:0xf
    v_and_b32_dpp v25, v12, v7 row_newbcast:9 row_mask:0xf bank_mask:0xf
    v_and_b32_dpp v26, v12, v8 row_newbcast:9 row_mask:0xf bank_mask:0xf
    v_and_b32_dpp v27, v12, v9 row_newbcast:9 row_mask:0xf bank_mask:0xf
    v_mfma_f32_16x16x32_bf16 v[16:19], v[96:99], v[20:23], v[16:19]
    v_and_b32_dpp v20, v12, v6 row_newbcast:10 row_mask:0xf bank_mask:0xf
    v_and_b32_dpp v21, v12, v7 row_newbcast:10 row_mask:0xf bank_mask:0xf
    v_and_b32_dpp v22, v12, v8 row_newbcast:10 row_mask:0xf bank_mask:0xf
    v_and_b32_dpp v23, v12, v9 row_newbcast:10 row_mask:0xf bank_mask:0xf
    v_mfma_f32_16x16x32_bf16 v[16:19], v[100:103], v[24:27], v[16:19]
    v_and_b32_dpp v24, v12, v6 row_newbcast:11 row_mask:0xf bank_mask:0xf
    v_and_b32_dpp v25, v12, v7 row_newbcast:11 row_mask:0xf bank_mask:0xf
    v_and_b32_dpp v26, v12, v8 row_newbcast:11 row_mask:0xf bank_mask:0xf
    v_and_b32_dpp v27, v12, v9 row_newbcast:11 row_mask:0xf bank_mask:0xf
    v_mfma_f32_16x16x32_bf16 v[16:19], v[104:107], v[20:23], v[16:19]
    v_and_b32_dpp v20, v12, v6 row_newbcast:12 row_mask:0xf bank_mask:0xf
    v_and_b32_dpp v21, v12, v7 row_newbcast:12 row_mask:0xf bank_mask:0xf
    v_and_b32_dpp v22, v12, v8 row_newbcast:12 row_mask:0xf bank_mask:0xf
    v_and_b32_dpp v23, v12, v9 row_newbcast:12 row_mask:0xf bank_mask:0xf
    v_mfma_f32_16x16x32_bf16 v[16:19], v[108:111], v[24:27], v[16:19]
    v_and_b32_dpp v24, v12, v6 row_newbcast:13 row_mask:0xf bank_mask:0xf
    v_and_b32_dpp v25, v12, v7 row_newbcast:13 row_mask:0xf bank_mask:0xf
    v_and_b32_dpp v26, v12, v8 row_newbcast:13 row_mask:0xf bank_mask:0xf
    v_and_b32_dpp v27, v12, v9 row_newbcast:13 row_mask:0xf bank_mask:0xf
    v_mfma_f32_16x16x32_bf16 v[16:19], v[112:115], v[20:23], v[16:19]
    v_and_b32_dpp v20, v12, v6 row_newbcast:14 row_mask:0xf bank_mask:0xf
    v_and_b32_dpp v21, v12, v7 row_newbcast:14 row_mask:0xf bank_mask:0xf
    v_and_b32_dpp v22, v12, v8 row_newbcast:14 row_mask:0xf bank_mask:0xf
    v_and_b32_dpp v23, v12, v9 row_newbcast:14 row_mask:0xf bank_mask:0xf
    v_mfma_f32_16x16x32_bf16 v[16:19], v[116:119], v[24:27], v[16:19]
    v_and_b32_dpp v24, v12, v6 row_newbcast:15 row_mask:0xf bank_mask:0xf
    v_and_b32_dpp v25, v12, v7 row_newbcast:15 row_mask:0xf bank_mask:0xf
    v_and_b32_dpp v26, v12, v8 row_newbcast:15 row_mask:0xf bank_mask:0xf
    v_and_b32_dpp v27, v12, v9 row_newbcast:15 row_mask:0xf bank_mask:0xf
    v_mfma_f32_16x16x32_bf16 v[16:19], v[120:123], v[20:23], v[16:19]
    v_and_b32_dpp v20, v13, v6 row_newbcast:0 row_mask:0xf bank_mask:0xf
    v_and_b32_dpp v21, v13, v7 row_newbcast:0 row_mask:0xf bank_mask:0xf
    v_and_b32_dpp v22, v13, v8 row_newbcast:0 row_mask:0xf bank_mask:0xf
    v_and_b32_dpp v23, v13, v9 row_newbcast:0 row_mask:0xf bank_mask:0xf
    v_mfma_f32_16x16x32_bf16 v[16:19], v[124:127], v[24:27], v[16:19]
    v_and_b32_dpp v24, v13, v6 row_newbcast:1 row_mask:0xf bank_mask:0xf
    v_and_b32_dpp v25, v13, v7 row_newbcast:1 row_mask:0xf bank_mask:0xf
    v_and_b32_dpp v26, v13, v8 row_newbcast:1 row_mask:0xf bank_mask:0xf
    v_and_b32_dpp v27, v13, v9 row_newbcast:1 row_mask:0xf bank_mask:0xf
    v_mfma_f32_16x16x32_bf16 v[16:19], v[128:131], v[20:23], v[16:19]
    v_and_b32_dpp v20, v13, v6 row_newbcast:2 row_mask:0xf bank_mask:0xf
    v_and_b32_dpp v21, v13, v7 row_newbcast:2 row_mask:0xf bank_mask:0xf
    v_and_b32_dpp v22, v13, v8 row_newbcast:2 row_mask:0xf bank_mask:0xf
    v_and_b32_dpp v23, v13, v9 row_newbcast:2 row_mask:0xf bank_mask:0xf
    v_mfma_f32_16x16x32_bf16 v[16:19], v[132:135], v[24:27], v[16:19]
    v_and_b32_dpp v24, v13, v6 row_newbcast:3 row_mask:0xf bank_mask:0xf
    v_and_b32_dpp v25, v13, v7 row_newbcast:3 row_mask:0xf bank_mask:0xf
    v_and_b32_dpp v26, v13, v8 row_newbcast:3 row_mask:0xf bank_mask:0xf
    v_and_b32_dpp v27, v13, v9 row_newbcast:3 row_mask:0xf bank_mask:0xf
    v_mfma_f32_16x16x32_bf16 v[16:19], v[136:139], v[20:23], v[16:19]
    v_and_b32_dpp v20, v13, v6 row_newbcast:4 row_mask:0xf bank_mask:0xf
    v_and_b32_dpp v21, v13, v7 row_newbcast:4 row_mask:0xf bank_mask:0xf
    v_and_b32_dpp v22, v13, v8 row_newbcast:4 row_mask:0xf bank_mask:0xf
    v_and_b32_dpp v23, v13, v9 row_newbcast:4 row_mask:0xf bank_mask:0xf
    v_mfma_f32_16x16x32_bf16 v[16:19], v[140:143], v[24:27], v[16:19]
    v_and_b32_dpp v24, v13, v6 row_newbcast:5 row_mask:0xf bank_mask:0xf
    v_and_b32_dpp v25, v13, v7 row_newbcast:5 row_mask:0xf bank_mask:0xf
    v_and_b32_dpp v26, v13, v8 row_newbcast:5 row_mask:0xf bank_mask:0xf
    v_and_b32_dpp v27, v13, v9 row_newbcast:5 row_mask:0xf bank_mask:0xf
    v_mfma_f32_16x16x32_bf16 v[16:19], v[144:147], v[20:23], v[16:19]
    v_and_b32_dpp v20, v13, v6 row_newbcast:6 row_mask:0xf bank_mask:0xf
    v_and_b32_dpp v21, v13, v7 row_newbcast:6 row_mask:0xf bank_mask:0xf
    v_and_b32_dpp v22, v13, v8 row_newbcast:6 row_mask:0xf bank_mask:0xf
    v_and_b32_dpp v23, v13, v9 row_newbcast:6 row_mask:0xf bank_mask:0xf
    v_mfma_f32_16x16x32_bf16 v[16:19], v[148:151], v[24:27], v[16:19]
    v_and_b32_dpp v24, v13, v6 row_newbcast:7 row_mask:0xf bank_mask:0xf
    v_and_b32_dpp v25, v13, v7 row_newbcast:7 row_mask:0xf bank_mask:0xf
    v_and_b32_dpp v26, v13, v8 row_newbcast:7 row_mask:0xf bank_mask:0xf
    v_and_b32_dpp v27, v13, v9 row_newbcast:7 row_mask:0xf bank_mask:0xf
    v_mfma_f32_16x16x32_bf16 v[16:19], v[152:155], v[20:23], v[16:19]
    v_and_b32_dpp v20, v13, v6 row_newbcast:8 row_mask:0xf bank_mask:0xf
    v_and_b32_dpp v21, v13, v7 row_newbcast:8 row_mask:0xf bank_mask:0xf
    v_and_b32_dpp v22, v13, v8 row_newbcast:8 row_mask:0xf bank_mask:0xf
    v_and_b32_dpp v23, v13, v9 row_newbcast:8 row_mask:0xf bank_mask:0xf
    v_mfma_f32_16x16x32_bf16 v[16:19], v[156:159], v[24:27], v[16:19]
    v_and_b32_dpp v24, v13, v6 row_newbcast:9 row_mask:0xf bank_mask:0xf
    v_and_b32_dpp v25, v13, v7 row_newbcast:9 row_mask:0xf bank_mask:0xf
    v_and_b32_dpp v26, v13, v8 row_newbcast:9 row_mask:0xf bank_mask:0xf
    v_and_b32_dpp v27, v13, v9 row_newbcast:9 row_mask:0xf bank_mask:0xf
    v_mfma_f32_16x16x32_bf16 v[16:19], v[160:163], v[20:23], v[16:19]
    v_and_b32_dpp v20, v13, v6 row_newbcast:10 row_mask:0xf bank_mask:0xf
    v_and_b32_dpp v21, v13, v7 row_newbcast:10 row_mask:0xf bank_mask:0xf
    v_and_b32_dpp v22, v13, v8 row_newbcast:10 row_mask:0xf bank_mask:0xf
    v_and_b32_dpp v23, v13, v9 row_newbcast:10 row_mask:0xf bank_mask:0xf
    v_mfma_f32_16x16x32_bf16 v[16:19], v[164:167], v[24:27], v[16:19]
    v_and_b32_dpp v24, v13, v6 row_newbcast:11 row_mask:0xf bank_mask:0xf
    v_and_b32_dpp v25, v13, v7 row_newbcast:11 row_mask:0xf bank_mask:0xf
    v_and_b32_dpp v26, v13, v8 row_newbcast:11 row_mask:0xf bank_mask:0xf
    v_and_b32_dpp v27, v13, v9 row_newbcast:11 row_mask:0xf bank_mask:0xf
    v_mfma_f32_16x16x32_bf16 v[16:19], v[168:171], v[20:23], v[16:19]
    v_and_b32_dpp v20, v13, v6 row_newbcast:12 row_mask:0xf bank_mask:0xf
    v_and_b32_dpp v21, v13, v7 row_newbcast:12 row_mask:0xf bank_mask:0xf
    v_and_b32_dpp v22, v13, v8 row_newbcast:12 row_mask:0xf bank_mask:0xf
    v_and_b32_dpp v23, v13, v9 row_newbcast:12 row_mask:0xf bank_mask:0xf
    v_mfma_f32_16x16x32_bf16 v[16:19], v[172:175], v[24:27], v[16:19]
    v_and_b32_dpp v24, v13, v6 row_newbcast:13 row_mask:0xf bank_mask:0xf
    v_and_b32_dpp v25, v13, v7 row_newbcast:13 row_mask:0xf bank_mask:0xf
    v_and_b32_dpp v26, v13, v8 row_newbcast:13 row_mask:0xf bank_mask:0xf
    v_and_b32_dpp v27, v13, v9 row_newbcast:13 row_mask:0xf bank_mask:0xf
    v_mfma_f32_16x16x32_bf16 v[16:19], v[176:179], v[20:23], v[16:19]
    v_and_b32_dpp v20, v13, v6 row_newbcast:14 row_mask:0xf bank_mask:0xf
    v_and_b32_dpp v21, v13, v7 row_newbcast:14 row_mask:0xf bank_mask:0xf
    v_and_b32_dpp v22, v13, v8 row_newbcast:14 row_mask:0xf bank_mask:0xf
    v_and_b32_dpp v23, v13, v9 row_newbcast:14 row_mask:0xf bank_mask:0xf
    v_mfma_f32_16x16x32_bf16 v[16:19], v[180:183], v[24:27], v[16:19]
    v_and_b32_dpp v24, v13, v6 row_newbcast:15 row_mask:0xf bank_mask:0xf
    v_and_b32_dpp v25, v13, v7 row_newbcast:15 row_mask:0xf bank_mask:0xf
    v_and_b32_dpp v26, v13, v8 row_newbcast:15 row_mask:0xf bank_mask:0xf
    v_and_b32_dpp v27, v13, v9 row_newbcast:15 row_mask:0xf bank_mask:0xf
    v_mfma_f32_16x16x32_bf16 v[16:19], v[184:187], v[20:23], v[16:19]
    s_nop 0
    v_mfma_f32_16x16x32_bf16 v[16:19], v[188:191], v[24:27], v[16:19]
    s_mul_i32 s25, s4, 5
    s_add_u32 s25, s25, s5
    s_lshl_b32 s25, s25, 9
    s_add_u32 s25, s25, 131072
    s_call_b64 s[30:31], L_pub
    s_sleep 30
    s_branch L_q1
L_q0:
    s_waitcnt lgkmcnt(0)
    s_mul_i32 s64, s64, 1664525
    s_add_u32 s64, s64, 1013904223
    s_movk_i32 s69, 0xff
    s_sleep 95
L_q2:
    s_call_b64 s[84:85], L_plan
    s_sleep 95
L_q1:
    s_call_b64 s[30:31], L_qsub
    s_branch L_tail
L_qsub:
    s_mul_i32 s24, s4, 2560
    s_add_u32 s24, s24, 131072
    s_add_u32 s25, s24, 4096
    v_lshrrev_b32 v36, 4, v10
    v_add_u32 v36, s64, v36
    s_mov_b32 s35, 2000000
L_gq_l:
    buffer_load_dwordx2 v[224:225], v10, s[16:19], s24 offen offset:0 sc1
    buffer_load_dwordx2 v[226:227], v10, s[16:19], s24 offen offset:512 sc1
    buffer_load_dwordx2 v[228:229], v10, s[16:19], s24 offen offset:1024 sc1
    buffer_load_dwordx2 v[230:231], v10, s[16:19], s24 offen offset:1536 sc1
    buffer_load_dwordx2 v[232:233], v10, s[16:19], s24 offen offset:2048 sc1
    v_mov_b32 v34, 0
    s_waitcnt vmcnt(4)
    v_bitop3_b32 v34, v224, v36, v34 bitop3:0xbe
    v_bitop3_b32 v34, v225, v36, v34 bitop3:0xbe
    s_waitcnt vmcnt(3)
    v_bitop3_b32 v34, v226, v36, v34 bitop3:0xbe
    v_bitop3_b32 v34, v227, v36, v34 bitop3:0xbe
    v_pk_add_f32 v[40:41], v[224:225], v[226:227]
    s_waitcnt vmcnt(2)
    v_bitop3_b32 v34, v228, v36, v34 bitop3:0xbe
    v_bitop3_b32 v34, v229, v36, v34 bitop3:0xbe
    v_pk_add_f32 v[40:41], v[40:41], v[228:229]
    s_waitcnt vmcnt(1)
    v_bitop3_b32 v34, v230, v36, v34 bitop3:0xbe
    v_bitop3_b32 v34, v231, v36, v34 bitop3:0xbe
    v_pk_add_f32 v[40:41], v[40:41], v[230:231]
    s_waitcnt vmcnt(0)
    v_bitop3_b32 v34, v232, v36, v34 bitop3:0xbe
    v_bitop3_b32 v34, v233, v36, v34 bitop3:0xbe
    v_pk_add_f32 v[40:41], v[40:41], v[232:233]
    v_and_b32 v34, 15, v34
    v_cmp_ne_u32 vcc, 0, v34
    s_cbranch_vccz L_gq_x
    s_sub_u32 s35, s35, 1
    s_cbranch_scc1 L_gq_x
    s_sleep 8
    s_branch L_gq_l
L_gq_x:
    v_cvt_pk_bf16_f32 v40, v40, v41
    ds_write_b16 v14, v40 offset:4352
    ds_write_b16_d16_hi v14, v40 offset:4480
    s_waitcnt lgkmcnt(0)
    s_mov_b64 exec, 1
    v_mov_b32 v32, 0
    v_mov_b32 v33, 1
    ds_add_u32 v32, v33
    s_mov_b64 exec, -1
    s_setpc_b64 s[30:31]
L_plan:
    s_add_u32 s6, s4, 11
    s_and_b32 s6, s6, 31
    s_cmp_lt_u32 s6, 16
    s_cselect_b32 s88, 5, 3
    s_cmp_lt_u32 s4, 15
    s_cselect_b32 s89, 7, 3
    s_cselect_b32 s94, 2, 3
    s_cmp_lt_u32 s4, 5
    s_cselect_b32 s94, 7, s94
    s_cselect_b32 s95, 2, 9
    v_mov_b32 v54, 0
    s_mov_b32 s6, 5
    s_mov_b32 s7, 3
    v_writelane_b32 v54, s6, 0
    v_writelane_b32 v54, s6, 1
    v_writelane_b32 v54, s88, 2
    v_writelane_b32 v54, s7, 3
    v_writelane_b32 v54, s7, 4
    v_writelane_b32 v54, s89, 5
    v_writelane_b32 v54, s94, 6
    v_writelane_b32 v54, s95, 7
    v_mov_b32 v55, v54
    s_nop 1
    v_add_u32_dpp v55, v55, v55 row_shr:1 row_mask:0xf bank_mask:0xf
    s_nop 1
    v_add_u32_dpp v55, v55, v55 row_shr:2 row_mask:0xf bank_mask:0xf
    s_nop 1
    v_add_u32_dpp v55, v55, v55 row_shr:4 row_mask:0xf bank_mask:0xf
    v_mov_b32 v56, 0
    v_readlane_b32 s6, v55, 7
    s_nop 0
    s_lshl_b32 s97, s6, 2
    v_subrev_u32 v57, s6, v1
    v_add_u32 v57, 32, v57
    v_xor_b32 v57, 24, v57
    v_lshlrev_b32 v57, 14, v57
    v_add_u32 v57, 3670016, v57
    v_cmp_gt_u32 vcc, s6, v1
    s_nop 1
    v_cndmask_b32 v56, v56, v57, vcc
    v_readlane_b32 s6, v55, 6
    s_nop 1
    v_subrev_u32 v57, s6, v1
    v_add_u32 v57, 32, v57
    v_xor_b32 v57, 16, v57
    v_lshlrev_b32 v57, 14, v57
    v_add_u32 v57, 3145728, v57
    v_cmp_gt_u32 vcc, s6, v1
    s_nop 1
    v_cndmask_b32 v56, v56, v57, vcc
    v_readlane_b32 s6, v55, 5
    s_nop 1
    v_subrev_u32 v57, s6, v1
    v_add_u32 v57, 32, v57
    v_xor_b32 v57, 8, v57
    v_lshlrev_b32 v57, 14, v57
    v_add_u32 v57, 2621440, v57
    v_cmp_gt_u32 vcc, s6, v1
    s_nop 1
    v_cndmask_b32 v56, v56, v57, vcc
    v_readlane_b32 s6, v55, 4
    s_nop 1
    v_subrev_u32 v57, s6, v1
    v_add_u32 v57, 32, v57
    v_xor_b32 v57, 0, v57
    v_lshlrev_b32 v57, 14, v57
    v_add_u32 v57, 2097152, v57
    v_cmp_gt_u32 vcc, s6, v1
    s_nop 1
    v_cndmask_b32 v56, v56, v57, vcc
    v_readlane_b32 s6, v55, 3
    s_nop 1
    v_subrev_u32 v57, s6, v1
    v_add_u32 v57, 32, v57
    v_xor_b32 v57, 24, v57
    v_lshlrev_b32 v57, 14, v57
    v_add_u32 v57, 1572864, v57
    v_cmp_gt_u32 vcc, s6, v1
    s_nop 1
    v_cndmask_b32 v56, v56, v57, vcc
    v_readlane_b32 s6, v55, 2
    s_nop 1
    v_subrev_u32 v57, s6, v1
    v_add_u32 v57, 32, v57
    v_xor_b32 v57, 16, v57
    v_lshlrev_b32 v57, 14, v57
    v_add_u32 v57, 1048576, v57
    v_cmp_gt_u32 vcc, s6, v1
    s_nop 1
    v_cndmask_b32 v56, v56, v57, vcc
    v_readlane_b32 s6, v55, 1
    s_nop 1
    v_subrev_u32 v57, s6, v1
    v_add_u32 v57, 32, v57
    v_xor_b32 v57, 8, v57
    v_lshlrev_b32 v57, 14, v57
    v_add_u32 v57, 524288, v57
    v_cmp_gt_u32 vcc, s6, v1
    s_nop 1
    v_cndmask_b32 v56, v56, v57, vcc
    v_readlane_b32 s6, v55, 0
    s_nop 1
    v_subrev_u32 v57, s6, v1
    v_add_u32 v57, 32, v57
    v_xor_b32 v57, 0, v57
    v_lshlrev_b32 v57, 14, v57
    v_add_u32 v57, 0, v57
    v_cmp_gt_u32 vcc, s6, v1
    s_nop 1
    v_cndmask_b32 v56, v56, v57, vcc
    v_readlane_b32 s6, v54, s5
    s_nop 0
    s_sub_u32 s6, 31, s6
    s_lshr_b32 s6, s6, 1
    s_lshl_b32 s96, s6, 4
    v_lshlrev_b32 v57, 2, v1
    ds_write_b32 v57, v56 offset:1792
    s_setpc_b64 s[84:85]
L_str:
    s_load_dword s64, s[62:63], 0
    s_mov_b32 s16, s62
    s_mov_b32 s17, s63
    s_mov_b32 s18, 2097152
    s_mov_b32 s19, 0x20000
    v_mov_b32 v4, 1069066811
    v_mov_b32 v5, 0
    v_mov_b32 v10, 0
    v_mov_b32 v23, 0xff800000
    v_and_b32 v12, 60, v1
    s_lshl_b32 s6, s3, 11
    s_add_u32 s6, s6, 9216
    v_add_u32 v12, s6, v12
    s_add_u32 s6, s4, 11
    s_and_b32 s6, s6, 31
    s_cmp_lt_u32 s6, 16
    s_cselect_b32 s20, 5, 3
    s_cmp_lt_u32 s4, 15
    s_cselect_b32 s21, 7, 3
    s_cselect_b32 s22, 2, 3
    s_cmp_lt_u32 s4, 5
    s_cselect_b32 s22, 7, s22
    s_cselect_b32 s23, 2, 9
    s_mov_b32 s28, 5
    s_cmp_eq_u32 s5, 2
    s_cselect_b32 s28, s20, s28
    s_cmp_gt_u32 s5, 2
    s_cselect_b32 s28, 3, s28
    s_cmp_eq_u32 s5, 5
    s_cselect_b32 s28, s21, s28
    s_cmp_eq_u32 s5, 6
    s_cselect_b32 s28, s22, s28
    s_cmp_eq_u32 s5, 7
    s_cselect_b32 s28, s23, s28
    s_sub_u32 s67, 31, s28
    s_lshl_b32 s67, s67, 14
    s_lshl_b32 s7, s5, 19
    s_add_u32 s67, s67, s7
    s_bitcmp1_b32 s28, 0
    s_mov_b32 s68, 0x7f800000
    s_cselect_b32 s68, 0xff800000, s68
    s_lshr_b32 s28, s28, 1
    s_sub_u32 s29, 16, s28
    s_sub_u32 s28, s29, 8
    s_waitcnt vmcnt(5)
    buffer_load_dwordx4 v[56:59], v11, s[8:11], s26 offen offset:2048 nt
    s_waitcnt vmcnt(5)
    buffer_load_dwordx4 v[60:63], v11, s[8:11], s26 offen offset:3072 nt
    s_add_u32 s66, s66, 16384
    s_xor_b32 s26, s66, s89
    s_waitcnt vmcnt(5)
    buffer_load_dwordx4 v[64:67], v11, s[8:11], s26 offen offset:0 nt
    s_waitcnt vmcnt(5)
    buffer_load_dwordx4 v[68:71], v11, s[8:11], s26 offen offset:1024 nt
    s_waitcnt vmcnt(5)
    buffer_load_dwordx4 v[72:75], v11, s[8:11], s26 offen offset:2048 nt
    s_waitcnt vmcnt(5)
    buffer_load_dwordx4 v[76:79], v11, s[8:11], s26 offen offset:3072 nt
    s_add_u32 s66, s66, 16384
    s_xor_b32 s26, s66, s89
    s_waitcnt vmcnt(5)
    buffer_load_dwordx4 v[80:83], v11, s[8:11], s26 offen offset:0 nt
    s_waitcnt vmcnt(5)
    buffer_load_dwordx4 v[84:87], v11, s[8:11], s26 offen offset:1024 nt
    s_waitcnt vmcnt(5)
    buffer_load_dwordx4 v[88:91], v11, s[8:11], s26 offen offset:2048 nt
    s_waitcnt vmcnt(5)
    buffer_load_dwordx4 v[92:95], v11, s[8:11], s26 offen offset:3072 nt
    s_add_u32 s66, s66, 16384
    s_xor_b32 s26, s66, s89
    s_waitcnt vmcnt(5)
    buffer_load_dwordx4 v[96:99], v11, s[8:11], s26 offen offset:0 nt
    s_waitcnt vmcnt(5)
    buffer_load_dwordx4 v[100:103], v11, s[8:11], s26 offen offset:1024 nt
    s_waitcnt vmcnt(5)
    buffer_load_dwordx4 v[104:107], v11, s[8:11], s26 offen offset:2048 nt
    s_waitcnt vmcnt(5)
    buffer_load_dwordx4 v[108:111], v11, s[8:11], s26 offen offset:3072 nt
    s_add_u32 s66, s66, 16384
    s_xor_b32 s26, s66, s89
    s_waitcnt vmcnt(5)
    buffer_load_dwordx4 v[112:115], v11, s[8:11], s26 offen offset:0 nt
    s_waitcnt vmcnt(5)
    buffer_load_dwordx4 v[116:119], v11, s[8:11], s26 offen offset:1024 nt
    s_waitcnt vmcnt(5)
    buffer_load_dwordx4 v[120:123], v11, s[8:11], s26 offen offset:2048 nt
    s_waitcnt vmcnt(5)
    buffer_load_dwordx4 v[124:127], v11, s[8:11], s26 offen offset:3072 nt
    s_add_u32 s66, s66, 16384
    s_xor_b32 s26, s66, s89
    s_waitcnt vmcnt(5)
    buffer_load_dwordx4 v[128:131], v11, s[8:11], s26 offen offset:0 nt
    s_waitcnt vmcnt(5)
    buffer_load_dwordx4 v[132:135], v11, s[8:11], s26 offen offset:1024 nt
    s_waitcnt vmcnt(5)
    buffer_load_dwordx4 v[136:139], v11, s[8:11], s26 offen offset:2048 nt
    s_waitcnt vmcnt(5)
    buffer_load_dwordx4 v[140:143], v11, s[8:11], s26 offen offset:3072 nt
    s_add_u32 s66, s66, 16384
    s_xor_b32 s26, s66, s89
    s_waitcnt vmcnt(5)
    buffer_load_dwordx4 v[144:147], v11, s[8:11], s26 offen offset:0 nt
    s_waitcnt vmcnt(5)
    buffer_load_dwordx4 v[148:151], v11, s[8:11], s26 offen offset:1024 nt
    s_waitcnt vmcnt(5)
    buffer_load_dwordx4 v[152:155], v11, s[8:11], s26 offen offset:2048 nt
    s_waitcnt vmcnt(5)
    buffer_load_dwordx4 v[156:159], v11, s[8:11], s26 offen offset:3072 nt
    s_add_u32 s66, s66, 16384
    s_xor_b32 s26, s66, s89
    s_waitcnt vmcnt(5)
    buffer_load_dwordx4 v[160:163], v11, s[8:11], s26 offen offset:0 nt
    s_waitcnt vmcnt(5)
    buffer_load_dwordx4 v[164:167], v11, s[8:11], s26 offen offset:1024 nt
    s_waitcnt vmcnt(5)
    buffer_load_dwordx4 v[168:171], v11, s[8:11], s26 offen offset:2048 nt
    s_waitcnt vmcnt(5)
    buffer_load_dwordx4 v[172:175], v11, s[8:11], s26 offen offset:3072 nt
    s_add_u32 s66, s66, 16384
    s_xor_b32 s26, s66, s89
    s_waitcnt vmcnt(5)
    buffer_load_dwordx4 v[176:179], v11, s[8:11], s26 offen offset:0 nt
    s_waitcnt vmcnt(5)
    buffer_load_dwordx4 v[180:183], v11, s[8:11], s26 offen offset:1024 nt
    s_waitcnt vmcnt(5)
    buffer_load_dwordx4 v[184:187], v11, s[8:11], s26 offen offset:2048 nt
    s_waitcnt vmcnt(5)
    buffer_load_dwordx4 v[188:191], v11, s[8:11], s26 offen offset:3072 nt
    s_add_u32 s66, s66, 16384
    s_xor_b32 s26, s66, s89
    s_waitcnt vmcnt(5)
    buffer_load_dwordx4 v[192:195], v11, s[8:11], s26 offen offset:0 nt
    s_waitcnt vmcnt(5)
    buffer_load_dwordx4 v[196:199], v11, s[8:11], s26 offen offset:1024 nt
    s_waitcnt vmcnt(5)
    buffer_load_dwordx4 v[200:203], v11, s[8:11], s26 offen offset:2048 nt
    s_waitcnt vmcnt(5)
    buffer_load_dwordx4 v[204:207], v11, s[8:11], s26 offen offset:3072 nt
    s_add_u32 s66, s66, 16384
    s_xor_b32 s26, s66, s89
    s_waitcnt vmcnt(5)
    buffer_load_dwordx4 v[208:211], v11, s[8:11], s26 offen offset:0 nt
    s_waitcnt vmcnt(5)
    buffer_load_dwordx4 v[212:215], v11, s[8:11], s26 offen offset:1024 nt
    s_waitcnt vmcnt(5)
    buffer_load_dwordx4 v[216:219], v11, s[8:11], s26 offen offset:2048 nt
    s_waitcnt vmcnt(5)
    buffer_load_dwordx4 v[220:223], v11, s[8:11], s26 offen offset:3072 nt
    s_add_u32 s66, s66, 16384
    s_xor_b32 s26, s66, s89
    s_waitcnt vmcnt(5)
    buffer_load_dwordx4 v[224:227], v11, s[8:11], s26 offen offset:0 nt
    s_waitcnt vmcnt(5)
    buffer_load_dwordx4 v[228:231], v11, s[8:11], s26 offen offset:1024 nt
    s_waitcnt vmcnt(5)
    buffer_load_dwordx4 v[232:235], v11, s[8:11], s26 offen offset:2048 nt
    s_waitcnt vmcnt(5)
    buffer_load_dwordx4 v[236:239], v11, s[8:11], s26 offen offset:3072 nt
    s_add_u32 s66, s66, 16384
    s_xor_b32 s26, s66, s89
    s_waitcnt vmcnt(5)
    buffer_load_dwordx4 v[240:243], v11, s[8:11], s26 offen offset:0 nt
    s_waitcnt vmcnt(5)
    buffer_load_dwordx4 v[244:247], v11, s[8:11], s26 offen offset:1024 nt
    s_waitcnt vmcnt(5)
    buffer_load_dwordx4 v[248:251], v11, s[8:11], s26 offen offset:2048 nt
    s_waitcnt vmcnt(5)
    buffer_load_dwordx4 v[252:255], v11, s[8:11], s26 offen offset:3072 nt
    s_add_u32 s66, s66, 16384
    s_xor_b32 s26, s66, s89
    s_waitcnt lgkmcnt(0)
    s_mul_i32 s64, s64, 1664525
    s_add_u32 s64, s64, 1013904223
    s_movk_i32 s69, 0xff
    s_mov_b32 s35, 2840909
    v_mov_b32 v16, 0
Lw_5:
    s_sub_u32 s35, s35, 1
    s_cbranch_scc1 Lx_6
    ds_read_b32 v17, v16
    s_waitcnt lgkmcnt(0)
    v_readfirstlane_b32 s34, v17
    s_nop 0
    s_cmp_ge_u32 s34, 1
    s_cbranch_scc1 Lx_6
    s_sleep 1
    s_branch Lw_5
Lx_6:
    v_lshlrev_b32 v16, 4, v2
    ds_read_b128 v[0:3], v16 offset:4352
    s_waitcnt lgkmcnt(0)
    v_dot2_f32_bf16 v16, v64, v0, 0
    v_dot2_f32_bf16 v16, v65, v1, v16
    v_dot2_f32_bf16 v16, v66, v2, v16
    v_dot2_f32_bf16 v16, v67, v3, v16
    v_dot2_f32_bf16 v17, v68, v0, 0
    v_dot2_f32_bf16 v17, v69, v1, v17
    v_dot2_f32_bf16 v17, v70, v2, v17
    v_dot2_f32_bf16 v17, v71, v3, v17
    v_dot2_f32_bf16 v18, v72, v0, 0
    v_dot2_f32_bf16 v18, v73, v1, v18
    v_dot2_f32_bf16 v18, v74, v2, v18
    v_dot2_f32_bf16 v18, v75, v3, v18
    v_dot2_f32_bf16 v19, v76, v0, 0
    v_dot2_f32_bf16 v19, v77, v1, v19
    v_dot2_f32_bf16 v19, v78, v2, v19
    v_dot2_f32_bf16 v19, v79, v3, v19
    v_add_f32_dpp v20, v16, v16 row_ror:8 row_mask:0xf bank_mask:0x3
    v_add_f32_dpp v20, v17, v17 row_ror:8 row_mask:0xf bank_mask:0xc
    v_add_f32_dpp v21, v18, v18 row_ror:8 row_mask:0xf bank_mask:0x3
    v_add_f32_dpp v21, v19, v19 row_ror:8 row_mask:0xf bank_mask:0xc
    v_add_f32_dpp v22, v20, v20 row_half_mirror row_mask:0xf bank_mask:0x5
    s_nop 0
    v_add_f32_dpp v22, v21, v21 row_half_mirror row_mask:0xf bank_mask:0xa
    s_nop 1
    v_add_f32_dpp v22, v22, v22 quad_perm:[1,0,3,2] row_mask:0xf bank_mask:0xf
    s_nop 1
    v_add_f32_dpp v22, v22, v22 quad_perm:[2,3,0,1] row_mask:0xf bank_mask:0xf
    v_cvt_pk_bf16_f32 v22, v22, v22
    v_and_b32 v22, 0xffff0000, v22
    v_mul_f32 v22, 1035273459, v22
    v_cvt_pk_bf16_f32 v22, v22, v22
    v_and_b32 v22, 0xffff0000, v22
    v_max_f32 v23, v23, v22
    ds_write_b32 v12, v22 offset:128
    buffer_load_dwordx4 v[64:67], v11, s[8:11], s26 offen offset:0 nt
    buffer_load_dwordx4 v[68:71], v11, s[8:11], s26 offen offset:1024 nt
    buffer_load_dwordx4 v[72:75], v11, s[8:11], s26 offen offset:2048 nt
    buffer_load_dwordx4 v[76:79], v11, s[8:11], s26 offen offset:3072 nt
    s_add_u32 s66, s66, 16384
    s_xor_b32 s26, s66, s89
    v_dot2_f32_bf16 v16, v80, v0, 0
    v_dot2_f32_bf16 v16, v81, v1, v16
    v_dot2_f32_bf16 v16, v82, v2, v16
    v_dot2_f32_bf16 v16, v83, v3, v16
    v_dot2_f32_bf16 v17, v84, v0, 0
    v_dot2_f32_bf16 v17, v85, v1, v17
    v_dot2_f32_bf16 v17, v86, v2, v17
    v_dot2_f32_bf16 v17, v87, v3, v17
    v_dot2_f32_bf16 v18, v88, v0, 0
    v_dot2_f32_bf16 v18, v89, v1, v18
    v_dot2_f32_bf16 v18, v90, v2, v18
    v_dot2_f32_bf16 v18, v91, v3, v18
    v_dot2_f32_bf16 v19, v92, v0, 0
    v_dot2_f32_bf16 v19, v93, v1, v19
    v_dot2_f32_bf16 v19, v94, v2, v19
    v_dot2_f32_bf16 v19, v95, v3, v19
    v_add_f32_dpp v20, v16, v16 row_ror:8 row_mask:0xf bank_mask:0x3
    v_add_f32_dpp v20, v17, v17 row_ror:8 row_mask:0xf bank_mask:0xc
    v_add_f32_dpp v21, v18, v18 row_ror:8 row_mask:0xf bank_mask:0x3
    v_add_f32_dpp v21, v19, v19 row_ror:8 row_mask:0xf bank_mask:0xc
    v_add_f32_dpp v22, v20, v20 row_half_mirror row_mask:0xf bank_mask:0x5
    s_nop 0
    v_add_f32_dpp v22, v21, v21 row_half_mirror row_mask:0xf bank_mask:0xa
    s_nop 1
    v_add_f32_dpp v22, v22, v22 quad_perm:[1,0,3,2] row_mask:0xf bank_mask:0xf
    s_nop 1
    v_add_f32_dpp v22, v22, v22 quad_perm:[2,3,0,1] row_mask:0xf bank_mask:0xf
    v_cvt_pk_bf16_f32 v22, v22, v22
    v_and_b32 v22, 0xffff0000, v22
    v_mul_f32 v22, 1035273459, v22
    v_cvt_pk_bf16_f32 v22, v22, v22
    v_and_b32 v22, 0xffff0000, v22
    v_max_f32 v23, v23, v22
    ds_write_b32 v12, v22 offset:192
    v_dot2_f32_bf16 v16, v32, v0, 0
    v_dot2_f32_bf16 v16, v33, v1, v16
    v_dot2_f32_bf16 v16, v34, v2, v16
    v_dot2_f32_bf16 v16, v35, v3, v16
    v_dot2_f32_bf16 v17, v36, v0, 0
    v_dot2_f32_bf16 v17, v37, v1, v17
    v_dot2_f32_bf16 v17, v38, v2, v17
    v_dot2_f32_bf16 v17, v39, v3, v17
    v_dot2_f32_bf16 v18, v40, v0, 0
    v_dot2_f32_bf16 v18, v41, v1, v18
    v_dot2_f32_bf16 v18, v42, v2, v18
    v_dot2_f32_bf16 v18, v43, v3, v18
    v_dot2_f32_bf16 v19, v44, v0, 0
    v_dot2_f32_bf16 v19, v45, v1, v19
    v_dot2_f32_bf16 v19, v46, v2, v19
    v_dot2_f32_bf16 v19, v47, v3, v19
    v_add_f32_dpp v20, v16, v16 row_ror:8 row_mask:0xf bank_mask:0x3
    v_add_f32_dpp v20, v17, v17 row_ror:8 row_mask:0xf bank_mask:0xc
    v_add_f32_dpp v21, v18, v18 row_ror:8 row_mask:0xf bank_mask:0x3
    v_add_f32_dpp v21, v19, v19 row_ror:8 row_mask:0xf bank_mask:0xc
    v_add_f32_dpp v22, v20, v20 row_half_mirror row_mask:0xf bank_mask:0x5
    s_nop 0
    v_add_f32_dpp v22, v21, v21 row_half_mirror row_mask:0xf bank_mask:0xa
    s_nop 1
    v_add_f32_dpp v22, v22, v22 quad_perm:[1,0,3,2] row_mask:0xf bank_mask:0xf
    s_nop 1
    v_add_f32_dpp v22, v22, v22 quad_perm:[2,3,0,1] row_mask:0xf bank_mask:0xf
    v_cvt_pk_bf16_f32 v22, v22, v22
    v_and_b32 v22, 0xffff0000, v22
    v_mul_f32 v22, 1035273459, v22
    v_cvt_pk_bf16_f32 v22, v22, v22
    v_and_b32 v22, 0xffff0000, v22
    v_max_f32 v23, v23, v22
    ds_write_b32 v12, v22 offset:0
    v_dot2_f32_bf16 v16, v48, v0, 0
    v_dot2_f32_bf16 v16, v49, v1, v16
    v_dot2_f32_bf16 v16, v50, v2, v16
    v_dot2_f32_bf16 v16, v51, v3, v16
    v_dot2_f32_bf16 v17, v52, v0, 0
    v_dot2_f32_bf16 v17, v53, v1, v17
    v_dot2_f32_bf16 v17, v54, v2, v17
    v_dot2_f32_bf16 v17, v55, v3, v17
    v_dot2_f32_bf16 v18, v56, v0, 0
    v_dot2_f32_bf16 v18, v57, v1, v18
    v_dot2_f32_bf16 v18, v58, v2, v18
    v_dot2_f32_bf16 v18, v59, v3, v18
    v_dot2_f32_bf16 v19, v60, v0, 0
    v_dot2_f32_bf16 v19, v61, v1, v19
    v_dot2_f32_bf16 v19, v62, v2, v19
    v_dot2_f32_bf16 v19, v63, v3, v19
    v_add_f32_dpp v20, v16, v16 row_ror:8 row_mask:0xf bank_mask:0x3
    v_add_f32_dpp v20, v17, v17 row_ror:8 row_mask:0xf bank_mask:0xc
    v_add_f32_dpp v21, v18, v18 row_ror:8 row_mask:0xf bank_mask:0x3
    v_add_f32_dpp v21, v19, v19 row_ror:8 row_mask:0xf bank_mask:0xc
    v_add_f32_dpp v22, v20, v20 row_half_mirror row_mask:0xf bank_mask:0x5
    s_nop 0
    v_add_f32_dpp v22, v21, v21 row_half_mirror row_mask:0xf bank_mask:0xa
    s_nop 1
    v_add_f32_dpp v22, v22, v22 quad_perm:[1,0,3,2] row_mask:0xf bank_mask:0xf
    s_nop 1
    v_add_f32_dpp v22, v22, v22 quad_perm:[2,3,0,1] row_mask:0xf bank_mask:0xf
    v_cvt_pk_bf16_f32 v22, v22, v22
    v_and_b32 v22, 0xffff0000, v22
    v_mul_f32 v22, 1035273459, v22
    v_cvt_pk_bf16_f32 v22, v22, v22
    v_and_b32 v22, 0xffff0000, v22
    v_max_f32 v23, v23, v22
    ds_write_b32 v12, v22 offset:64
    v_dot2_f32_bf16 v16, v96, v0, 0
    v_dot2_f32_bf16 v16, v97, v1, v16
    v_dot2_f32_bf16 v16, v98, v2, v16
    v_dot2_f32_bf16 v16, v99, v3, v16
    v_dot2_f32_bf16 v17, v100, v0, 0
    v_dot2_f32_bf16 v17, v101, v1, v17
    v_dot2_f32_bf16 v17, v102, v2, v17
    v_dot2_f32_bf16 v17, v103, v3, v17
    v_dot2_f32_bf16 v18, v104, v0, 0
    v_dot2_f32_bf16 v18, v105, v1, v18
    v_dot2_f32_bf16 v18, v106, v2, v18
    v_dot2_f32_bf16 v18, v107, v3, v18
    v_dot2_f32_bf16 v19, v108, v0, 0
    v_dot2_f32_bf16 v19, v109, v1, v19
    v_dot2_f32_bf16 v19, v110, v2, v19
    v_dot2_f32_bf16 v19, v111, v3, v19
    v_add_f32_dpp v20, v16, v16 row_ror:8 row_mask:0xf bank_mask:0x3
    v_add_f32_dpp v20, v17, v17 row_ror:8 row_mask:0xf bank_mask:0xc
    v_add_f32_dpp v21, v18, v18 row_ror:8 row_mask:0xf bank_mask:0x3
    v_add_f32_dpp v21, v19, v19 row_ror:8 row_mask:0xf bank_mask:0xc
    v_add_f32_dpp v22, v20, v20 row_half_mirror row_mask:0xf bank_mask:0x5
    s_nop 0
    v_add_f32_dpp v22, v21, v21 row_half_mirror row_mask:0xf bank_mask:0xa
    s_nop 1
    v_add_f32_dpp v22, v22, v22 quad_perm:[1,0,3,2] row_mask:0xf bank_mask:0xf
    s_nop 1
    v_add_f32_dpp v22, v22, v22 quad_perm:[2,3,0,1] row_mask:0xf bank_mask:0xf
    v_cvt_pk_bf16_f32 v22, v22, v22
    v_and_b32 v22, 0xffff0000, v22
    v_mul_f32 v22, 1035273459, v22
    v_cvt_pk_bf16_f32 v22, v22, v22
    v_and_b32 v22, 0xffff0000, v22
    v_max_f32 v23, v23, v22
    ds_write_b32 v12, v22 offset:256
    buffer_load_dwordx4 v[80:83], v11, s[8:11], s26 offen offset:0 nt
    buffer_load_dwordx4 v[84:87], v11, s[8:11], s26 offen offset:1024 nt
    buffer_load_dwordx4 v[88:91], v11, s[8:11], s26 offen offset:2048 nt
    buffer_load_dwordx4 v[92:95], v11, s[8:11], s26 offen offset:3072 nt
    s_add_u32 s66, s66, 16384
    s_xor_b32 s26, s66, s89
    v_dot2_f32_bf16 v16, v112, v0, 0
    v_dot2_f32_bf16 v16, v113, v1, v16
    v_dot2_f32_bf16 v16, v114, v2, v16
    v_dot2_f32_bf16 v16, v115, v3, v16
    v_dot2_f32_bf16 v17, v116, v0, 0
    v_dot2_f32_bf16 v17, v117, v1, v17
    v_dot2_f32_bf16 v17, v118, v2, v17
    v_dot2_f32_bf16 v17, v119, v3, v17
    v_dot2_f32_bf16 v18, v120, v0, 0
    v_dot2_f32_bf16 v18, v121, v1, v18
    v_dot2_f32_bf16 v18, v122, v2, v18
    v_dot2_f32_bf16 v18, v123, v3, v18
    v_dot2_f32_bf16 v19, v124, v0, 0
    v_dot2_f32_bf16 v19, v125, v1, v19
    v_dot2_f32_bf16 v19, v126, v2, v19
    v_dot2_f32_bf16 v19, v127, v3, v19
    v_add_f32_dpp v20, v16, v16 row_ror:8 row_mask:0xf bank_mask:0x3
    v_add_f32_dpp v20, v17, v17 row_ror:8 row_mask:0xf bank_mask:0xc
    v_add_f32_dpp v21, v18, v18 row_ror:8 row_mask:0xf bank_mask:0x3
    v_add_f32_dpp v21, v19, v19 row_ror:8 row_mask:0xf bank_mask:0xc
    v_add_f32_dpp v22, v20, v20 row_half_mirror row_mask:0xf bank_mask:0x5
    s_nop 0
    v_add_f32_dpp v22, v21, v21 row_half_mirror row_mask:0xf bank_mask:0xa
    s_nop 1
    v_add_f32_dpp v22, v22, v22 quad_perm:[1,0,3,2] row_mask:0xf bank_mask:0xf
    s_nop 1
    v_add_f32_dpp v22, v22, v22 quad_perm:[2,3,0,1] row_mask:0xf bank_mask:0xf
    v_cvt_pk_bf16_f32 v22, v22, v22
    v_and_b32 v22, 0xffff0000, v22
    v_mul_f32 v22, 1035273459, v22
    v_cvt_pk_bf16_f32 v22, v22, v22
    v_and_b32 v22, 0xffff0000, v22
    v_max_f32 v23, v23, v22
    ds_write_b32 v12, v22 offset:320
    v_dot2_f32_bf16 v16, v128, v0, 0
    v_dot2_f32_bf16 v16, v129, v1, v16
    v_dot2_f32_bf16 v16, v130, v2, v16
    v_dot2_f32_bf16 v16, v131, v3, v16
    v_dot2_f32_bf16 v17, v132, v0, 0
    v_dot2_f32_bf16 v17, v133, v1, v17
    v_dot2_f32_bf16 v17, v134, v2, v17
    v_dot2_f32_bf16 v17, v135, v3, v17
    v_dot2_f32_bf16 v18, v136, v0, 0
    v_dot2_f32_bf16 v18, v137, v1, v18
    v_dot2_f32_bf16 v18, v138, v2, v18
    v_dot2_f32_bf16 v18, v139, v3, v18
    v_dot2_f32_bf16 v19, v140, v0, 0
    v_dot2_f32_bf16 v19, v141, v1, v19
    v_dot2_f32_bf16 v19, v142, v2, v19
    v_dot2_f32_bf16 v19, v143, v3, v19
    v_add_f32_dpp v20, v16, v16 row_ror:8 row_mask:0xf bank_mask:0x3
    v_add_f32_dpp v20, v17, v17 row_ror:8 row_mask:0xf bank_mask:0xc
    v_add_f32_dpp v21, v18, v18 row_ror:8 row_mask:0xf bank_mask:0x3
    v_add_f32_dpp v21, v19, v19 row_ror:8 row_mask:0xf bank_mask:0xc
    v_add_f32_dpp v22, v20, v20 row_half_mirror row_mask:0xf bank_mask:0x5
    s_nop 0
    v_add_f32_dpp v22, v21, v21 row_half_mirror row_mask:0xf bank_mask:0xa
    s_nop 1
    v_add_f32_dpp v22, v22, v22 quad_perm:[1,0,3,2] row_mask:0xf bank_mask:0xf
    s_nop 1
    v_add_f32_dpp v22, v22, v22 quad_perm:[2,3,0,1] row_mask:0xf bank_mask:0xf
    v_cvt_pk_bf16_f32 v22, v22, v22
    v_and_b32 v22, 0xffff0000, v22
    v_mul_f32 v22, 1035273459, v22
    v_cvt_pk_bf16_f32 v22, v22, v22
    v_and_b32 v22, 0xffff0000, v22
    v_max_f32 v23, v23, v22
    ds_write_b32 v12, v22 offset:384
    v_dot2_f32_bf16 v16, v144, v0, 0
    v_dot2_f32_bf16 v16, v145, v1, v16
    v_dot2_f32_bf16 v16, v146, v2, v16
    v_dot2_f32_bf16 v16, v147, v3, v16
    v_dot2_f32_bf16 v17, v148, v0, 0
    v_dot2_f32_bf16 v17, v149, v1, v17
    v_dot2_f32_bf16 v17, v150, v2, v17
    v_dot2_f32_bf16 v17, v151, v3, v17
    v_dot2_f32_bf16 v18, v152, v0, 0
    v_dot2_f32_bf16 v18, v153, v1, v18
    v_dot2_f32_bf16 v18, v154, v2, v18
    v_dot2_f32_bf16 v18, v155, v3, v18
    v_dot2_f32_bf16 v19, v156, v0, 0
    v_dot2_f32_bf16 v19, v157, v1, v19
    v_dot2_f32_bf16 v19, v158, v2, v19
    v_dot2_f32_bf16 v19, v159, v3, v19
    v_add_f32_dpp v20, v16, v16 row_ror:8 row_mask:0xf bank_mask:0x3
    v_add_f32_dpp v20, v17, v17 row_ror:8 row_mask:0xf bank_mask:0xc
    v_add_f32_dpp v21, v18, v18 row_ror:8 row_mask:0xf bank_mask:0x3
    v_add_f32_dpp v21, v19, v19 row_ror:8 row_mask:0xf bank_mask:0xc
    v_add_f32_dpp v22, v20, v20 row_half_mirror row_mask:0xf bank_mask:0x5
    s_nop 0
    v_add_f32_dpp v22, v21, v21 row_half_mirror row_mask:0xf bank_mask:0xa
    s_nop 1
    v_add_f32_dpp v22, v22, v22 quad_perm:[1,0,3,2] row_mask:0xf bank_mask:0xf
    s_nop 1
    v_add_f32_dpp v22, v22, v22 quad_perm:[2,3,0,1] row_mask:0xf bank_mask:0xf
    v_cvt_pk_bf16_f32 v22, v22, v22
    v_and_b32 v22, 0xffff0000, v22
    v_mul_f32 v22, 1035273459, v22
    v_cvt_pk_bf16_f32 v22, v22, v22
    v_and_b32 v22, 0xffff0000, v22
    v_max_f32 v23, v23, v22
    ds_write_b32 v12, v22 offset:448
    v_dot2_f32_bf16 v16, v160, v0, 0
    v_dot2_f32_bf16 v16, v161, v1, v16
    v_dot2_f32_bf16 v16, v162, v2, v16
    v_dot2_f32_bf16 v16, v163, v3, v16
    v_dot2_f32_bf16 v17, v164, v0, 0
    v_dot2_f32_bf16 v17, v165, v1, v17
    v_dot2_f32_bf16 v17, v166, v2, v17
    v_dot2_f32_bf16 v17, v167, v3, v17
    v_dot2_f32_bf16 v18, v168, v0, 0
    v_dot2_f32_bf16 v18, v169, v1, v18
    v_dot2_f32_bf16 v18, v170, v2, v18
    v_dot2_f32_bf16 v18, v171, v3, v18
    v_dot2_f32_bf16 v19, v172, v0, 0
    v_dot2_f32_bf16 v19, v173, v1, v19
    v_dot2_f32_bf16 v19, v174, v2, v19
    v_dot2_f32_bf16 v19, v175, v3, v19
    v_add_f32_dpp v20, v16, v16 row_ror:8 row_mask:0xf bank_mask:0x3
    v_add_f32_dpp v20, v17, v17 row_ror:8 row_mask:0xf bank_mask:0xc
    v_add_f32_dpp v21, v18, v18 row_ror:8 row_mask:0xf bank_mask:0x3
    v_add_f32_dpp v21, v19, v19 row_ror:8 row_mask:0xf bank_mask:0xc
    v_add_f32_dpp v22, v20, v20 row_half_mirror row_mask:0xf bank_mask:0x5
    s_nop 0
    v_add_f32_dpp v22, v21, v21 row_half_mirror row_mask:0xf bank_mask:0xa
    s_nop 1
    v_add_f32_dpp v22, v22, v22 quad_perm:[1,0,3,2] row_mask:0xf bank_mask:0xf
    s_nop 1
    v_add_f32_dpp v22, v22, v22 quad_perm:[2,3,0,1] row_mask:0xf bank_mask:0xf
    v_cvt_pk_bf16_f32 v22, v22, v22
    v_and_b32 v22, 0xffff0000, v22
    v_mul_f32 v22, 1035273459, v22
    v_cvt_pk_bf16_f32 v22, v22, v22
    v_and_b32 v22, 0xffff0000, v22
    v_max_f32 v23, v23, v22
    ds_write_b32 v12, v22 offset:512
    buffer_load_dwordx4 v[32:35], v11, s[8:11], s26 offen offset:0 nt
    buffer_load_dwordx4 v[36:39], v11, s[8:11], s26 offen offset:1024 nt
    buffer_load_dwordx4 v[40:43], v11, s[8:11], s26 offen offset:2048 nt
    buffer_load_dwordx4 v[44:47], v11, s[8:11], s26 offen offset:3072 nt
    s_add_u32 s66, s66, 16384
    s_xor_b32 s26, s66, s89
    v_dot2_f32_bf16 v16, v176, v0, 0
    v_dot2_f32_bf16 v16, v177, v1, v16
    v_dot2_f32_bf16 v16, v178, v2, v16
    v_dot2_f32_bf16 v16, v179, v3, v16
    v_dot2_f32_bf16 v17, v180, v0, 0
    v_dot2_f32_bf16 v17, v181, v1, v17
    v_dot2_f32_bf16 v17, v182, v2, v17
    v_dot2_f32_bf16 v17, v183, v3, v17
    v_dot2_f32_bf16 v18, v184, v0, 0
    v_dot2_f32_bf16 v18, v185, v1, v18
    v_dot2_f32_bf16 v18, v186, v2, v18
    v_dot2_f32_bf16 v18, v187, v3, v18
    v_dot2_f32_bf16 v19, v188, v0, 0
    v_dot2_f32_bf16 v19, v189, v1, v19
    v_dot2_f32_bf16 v19, v190, v2, v19
    v_dot2_f32_bf16 v19, v191, v3, v19
    v_add_f32_dpp v20, v16, v16 row_ror:8 row_mask:0xf bank_mask:0x3
    v_add_f32_dpp v20, v17, v17 row_ror:8 row_mask:0xf bank_mask:0xc
    v_add_f32_dpp v21, v18, v18 row_ror:8 row_mask:0xf bank_mask:0x3
    v_add_f32_dpp v21, v19, v19 row_ror:8 row_mask:0xf bank_mask:0xc
    v_add_f32_dpp v22, v20, v20 row_half_mirror row_mask:0xf bank_mask:0x5
    s_nop 0
    v_add_f32_dpp v22, v21, v21 row_half_mirror row_mask:0xf bank_mask:0xa
    s_nop 1
    v_add_f32_dpp v22, v22, v22 quad_perm:[1,0,3,2] row_mask:0xf bank_mask:0xf
    s_nop 1
    v_add_f32_dpp v22, v22, v22 quad_perm:[2,3,0,1] row_mask:0xf bank_mask:0xf
    v_cvt_pk_bf16_f32 v22, v22, v22
    v_and_b32 v22, 0xffff0000, v22
    v_mul_f32 v22, 1035273459, v22
    v_cvt_pk_bf16_f32 v22, v22, v22
    v_and_b32 v22, 0xffff0000, v22
    v_max_f32 v23, v23, v22
    ds_write_b32 v12, v22 offset:576
    v_dot2_f32_bf16 v16, v192, v0, 0
    v_dot2_f32_bf16 v16, v193, v1, v16
    v_dot2_f32_bf16 v16, v194, v2, v16
    v_dot2_f32_bf16 v16, v195, v3, v16
    v_dot2_f32_bf16 v17, v196, v0, 0
    v_dot2_f32_bf16 v17, v197, v1, v17
    v_dot2_f32_bf16 v17, v198, v2, v17
    v_dot2_f32_bf16 v17, v199, v3, v17
    v_dot2_f32_bf16 v18, v200, v0, 0
    v_dot2_f32_bf16 v18, v201, v1, v18
    v_dot2_f32_bf16 v18, v202, v2, v18
    v_dot2_f32_bf16 v18, v203, v3, v18
    v_dot2_f32_bf16 v19, v204, v0, 0
    v_dot2_f32_bf16 v19, v205, v1, v19
    v_dot2_f32_bf16 v19, v206, v2, v19
    v_dot2_f32_bf16 v19, v207, v3, v19
    v_add_f32_dpp v20, v16, v16 row_ror:8 row_mask:0xf bank_mask:0x3
    v_add_f32_dpp v20, v17, v17 row_ror:8 row_mask:0xf bank_mask:0xc
    v_add_f32_dpp v21, v18, v18 row_ror:8 row_mask:0xf bank_mask:0x3
    v_add_f32_dpp v21, v19, v19 row_ror:8 row_mask:0xf bank_mask:0xc
    v_add_f32_dpp v22, v20, v20 row_half_mirror row_mask:0xf bank_mask:0x5
    s_nop 0
    v_add_f32_dpp v22, v21, v21 row_half_mirror row_mask:0xf bank_mask:0xa
    s_nop 1
    v_add_f32_dpp v22, v22, v22 quad_perm:[1,0,3,2] row_mask:0xf bank_mask:0xf
    s_nop 1
    v_add_f32_dpp v22, v22, v22 quad_perm:[2,3,0,1] row_mask:0xf bank_mask:0xf
    v_cvt_pk_bf16_f32 v22, v22, v22
    v_and_b32 v22, 0xffff0000, v22
    v_mul_f32 v22, 1035273459, v22
    v_cvt_pk_bf16_f32 v22, v22, v22
    v_and_b32 v22, 0xffff0000, v22
    v_max_f32 v23, v23, v22
    ds_write_b32 v12, v22 offset:640
    v_dot2_f32_bf16 v16, v208, v0, 0
    v_dot2_f32_bf16 v16, v209, v1, v16
    v_dot2_f32_bf16 v16, v210, v2, v16
    v_dot2_f32_bf16 v16, v211, v3, v16
    v_dot2_f32_bf16 v17, v212, v0, 0
    v_dot2_f32_bf16 v17, v213, v1, v17
    v_dot2_f32_bf16 v17, v214, v2, v17
    v_dot2_f32_bf16 v17, v215, v3, v17
    v_dot2_f32_bf16 v18, v216, v0, 0
    v_dot2_f32_bf16 v18, v217, v1, v18
    v_dot2_f32_bf16 v18, v218, v2, v18
    v_dot2_f32_bf16 v18, v219, v3, v18
    v_dot2_f32_bf16 v19, v220, v0, 0
    v_dot2_f32_bf16 v19, v221, v1, v19
    v_dot2_f32_bf16 v19, v222, v2, v19
    v_dot2_f32_bf16 v19, v223, v3, v19
    v_add_f32_dpp v20, v16, v16 row_ror:8 row_mask:0xf bank_mask:0x3
    v_add_f32_dpp v20, v17, v17 row_ror:8 row_mask:0xf bank_mask:0xc
    v_add_f32_dpp v21, v18, v18 row_ror:8 row_mask:0xf bank_mask:0x3
    v_add_f32_dpp v21, v19, v19 row_ror:8 row_mask:0xf bank_mask:0xc
    v_add_f32_dpp v22, v20, v20 row_half_mirror row_mask:0xf bank_mask:0x5
    s_nop 0
    v_add_f32_dpp v22, v21, v21 row_half_mirror row_mask:0xf bank_mask:0xa
    s_nop 1
    v_add_f32_dpp v22, v22, v22 quad_perm:[1,0,3,2] row_mask:0xf bank_mask:0xf
    s_nop 1
    v_add_f32_dpp v22, v22, v22 quad_perm:[2,3,0,1] row_mask:0xf bank_mask:0xf
    v_cvt_pk_bf16_f32 v22, v22, v22
    v_and_b32 v22, 0xffff0000, v22
    v_mul_f32 v22, 1035273459, v22
    v_cvt_pk_bf16_f32 v22, v22, v22
    v_and_b32 v22, 0xffff0000, v22
    v_max_f32 v23, v23, v22
    ds_write_b32 v12, v22 offset:704
    buffer_load_dwordx4 v[48:51], v11, s[8:11], s26 offen offset:0 nt
    buffer_load_dwordx4 v[52:55], v11, s[8:11], s26 offen offset:1024 nt
    buffer_load_dwordx4 v[56:59], v11, s[8:11], s26 offen offset:2048 nt
    buffer_load_dwordx4 v[60:63], v11, s[8:11], s26 offen offset:3072 nt
    s_waitcnt vmcnt(23)
    v_dot2_f32_bf16 v16, v224, v0, 0
    v_dot2_f32_bf16 v16, v225, v1, v16
    v_dot2_f32_bf16 v16, v226, v2, v16
    v_dot2_f32_bf16 v16, v227, v3, v16
    s_waitcnt vmcnt(22)
    v_dot2_f32_bf16 v17, v228, v0, 0
    v_dot2_f32_bf16 v17, v229, v1, v17
    v_dot2_f32_bf16 v17, v230, v2, v17
    v_dot2_f32_bf16 v17, v231, v3, v17
    s_waitcnt vmcnt(21)
    v_dot2_f32_bf16 v18, v232, v0, 0
    v_dot2_f32_bf16 v18, v233, v1, v18
    v_dot2_f32_bf16 v18, v234, v2, v18
    v_dot2_f32_bf16 v18, v235, v3, v18
    s_waitcnt vmcnt(20)
    v_dot2_f32_bf16 v19, v236, v0, 0
    v_dot2_f32_bf16 v19, v237, v1, v19
    v_dot2_f32_bf16 v19, v238, v2, v19
    v_dot2_f32_bf16 v19, v239, v3, v19
    v_add_f32_dpp v20, v16, v16 row_ror:8 row_mask:0xf bank_mask:0x3
    v_add_f32_dpp v20, v17, v17 row_ror:8 row_mask:0xf bank_mask:0xc
    v_add_f32_dpp v21, v18, v18 row_ror:8 row_mask:0xf bank_mask:0x3
    v_add_f32_dpp v21, v19, v19 row_ror:8 row_mask:0xf bank_mask:0xc
    v_add_f32_dpp v22, v20, v20 row_half_mirror row_mask:0xf bank_mask:0x5
    s_nop 0
    v_add_f32_dpp v22, v21, v21 row_half_mirror row_mask:0xf bank_mask:0xa
    s_nop 1
    v_add_f32_dpp v22, v22, v22 quad_perm:[1,0,3,2] row_mask:0xf bank_mask:0xf
    s_nop 1
    v_add_f32_dpp v22, v22, v22 quad_perm:[2,3,0,1] row_mask:0xf bank_mask:0xf
    v_cvt_pk_bf16_f32 v22, v22, v22
    v_and_b32 v22, 0xffff0000, v22
    v_mul_f32 v22, 1035273459, v22
    v_cvt_pk_bf16_f32 v22, v22, v22
    v_and_b32 v22, 0xffff0000, v22
    v_max_f32 v23, v23, v22
    ds_write_b32 v12, v22 offset:768
    s_waitcnt vmcnt(19)
    v_dot2_f32_bf16 v16, v240, v0, 0
    v_dot2_f32_bf16 v16, v241, v1, v16
    v_dot2_f32_bf16 v16, v242, v2, v16
    v_dot2_f32_bf16 v16, v243, v3, v16
    s_waitcnt vmcnt(18)
    v_dot2_f32_bf16 v17, v244, v0, 0
    v_dot2_f32_bf16 v17, v245, v1, v17
    v_dot2_f32_bf16 v17, v246, v2, v17
    v_dot2_f32_bf16 v17, v247, v3, v17
    s_waitcnt vmcnt(17)
    v_dot2_f32_bf16 v18, v248, v0, 0
    v_dot2_f32_bf16 v18, v249, v1, v18
    v_dot2_f32_bf16 v18, v250, v2, v18
    v_dot2_f32_bf16 v18, v251, v3, v18
    s_waitcnt vmcnt(16)
    v_dot2_f32_bf16 v19, v252, v0, 0
    v_dot2_f32_bf16 v19, v253, v1, v19
    v_dot2_f32_bf16 v19, v254, v2, v19
    v_dot2_f32_bf16 v19, v255, v3, v19
    v_add_f32_dpp v20, v16, v16 row_ror:8 row_mask:0xf bank_mask:0x3
    v_add_f32_dpp v20, v17, v17 row_ror:8 row_mask:0xf bank_mask:0xc
    v_add_f32_dpp v21, v18, v18 row_ror:8 row_mask:0xf bank_mask:0x3
    v_add_f32_dpp v21, v19, v19 row_ror:8 row_mask:0xf bank_mask:0xc
    v_add_f32_dpp v22, v20, v20 row_half_mirror row_mask:0xf bank_mask:0x5
    s_nop 0
    v_add_f32_dpp v22, v21, v21 row_half_mirror row_mask:0xf bank_mask:0xa
    s_nop 1
    v_add_f32_dpp v22, v22, v22 quad_perm:[1,0,3,2] row_mask:0xf bank_mask:0xf
    s_nop 1
    v_add_f32_dpp v22, v22, v22 quad_perm:[2,3,0,1] row_mask:0xf bank_mask:0xf
    v_cvt_pk_bf16_f32 v22, v22, v22
    v_and_b32 v22, 0xffff0000, v22
    v_mul_f32 v22, 1035273459, v22
    v_cvt_pk_bf16_f32 v22, v22, v22
    v_and_b32 v22, 0xffff0000, v22
    v_max_f32 v23, v23, v22
    ds_write_b32 v12, v22 offset:832
    s_sub_u32 s66, s66, 16384
    s_waitcnt vmcnt(15)
    v_dot2_f32_bf16 v16, v64, v0, 0
    v_dot2_f32_bf16 v16, v65, v1, v16
    v_dot2_f32_bf16 v16, v66, v2, v16
    v_dot2_f32_bf16 v16, v67, v3, v16
    s_waitcnt vmcnt(14)
    v_dot2_f32_bf16 v17, v68, v0, 0
    v_dot2_f32_bf16 v17, v69, v1, v17
    v_dot2_f32_bf16 v17, v70, v2, v17
    v_dot2_f32_bf16 v17, v71, v3, v17
    s_waitcnt vmcnt(13)
    v_dot2_f32_bf16 v18, v72, v0, 0
    v_dot2_f32_bf16 v18, v73, v1, v18
    v_dot2_f32_bf16 v18, v74, v2, v18
    v_dot2_f32_bf16 v18, v75, v3, v18
    s_waitcnt vmcnt(12)
    v_dot2_f32_bf16 v19, v76, v0, 0
    v_dot2_f32_bf16 v19, v77, v1, v19
    v_dot2_f32_bf16 v19, v78, v2, v19
    v_dot2_f32_bf16 v19, v79, v3, v19
    v_add_f32_dpp v20, v16, v16 row_ror:8 row_mask:0xf bank_mask:0x3
    v_add_f32_dpp v20, v17, v17 row_ror:8 row_mask:0xf bank_mask:0xc
    v_add_f32_dpp v21, v18, v18 row_ror:8 row_mask:0xf bank_mask:0x3
    v_add_f32_dpp v21, v19, v19 row_ror:8 row_mask:0xf bank_mask:0xc
    v_add_f32_dpp v22, v20, v20 row_half_mirror row_mask:0xf bank_mask:0x5
    s_nop 0
    v_add_f32_dpp v22, v21, v21 row_half_mirror row_mask:0xf bank_mask:0xa
    s_nop 1
    v_add_f32_dpp v22, v22, v22 quad_perm:[1,0,3,2] row_mask:0xf bank_mask:0xf
    s_nop 1
    v_add_f32_dpp v22, v22, v22 quad_perm:[2,3,0,1] row_mask:0xf bank_mask:0xf
    v_cvt_pk_bf16_f32 v22, v22, v22
    v_and_b32 v22, 0xffff0000, v22
    v_mul_f32 v22, 1035273459, v22
    v_cvt_pk_bf16_f32 v22, v22, v22
    v_and_b32 v22, 0xffff0000, v22
    v_max_f32 v23, v23, v22
    ds_write_b32 v12, v22 offset:896
    s_waitcnt vmcnt(11)
    v_dot2_f32_bf16 v16, v80, v0, 0
    v_dot2_f32_bf16 v16, v81, v1, v16
    v_dot2_f32_bf16 v16, v82, v2, v16
    v_dot2_f32_bf16 v16, v83, v3, v16
    s_waitcnt vmcnt(10)
    v_dot2_f32_bf16 v17, v84, v0, 0
    v_dot2_f32_bf16 v17, v85, v1, v17
    v_dot2_f32_bf16 v17, v86, v2, v17
    v_dot2_f32_bf16 v17, v87, v3, v17
    s_waitcnt vmcnt(9)
    v_dot2_f32_bf16 v18, v88, v0, 0
    v_dot2_f32_bf16 v18, v89, v1, v18
    v_dot2_f32_bf16 v18, v90, v2, v18
    v_dot2_f32_bf16 v18, v91, v3, v18
    s_waitcnt vmcnt(8)
    v_dot2_f32_bf16 v19, v92, v0, 0
    v_dot2_f32_bf16 v19, v93, v1, v19
    v_dot2_f32_bf16 v19, v94, v2, v19
    v_dot2_f32_bf16 v19, v95, v3, v19
    v_add_f32_dpp v20, v16, v16 row_ror:8 row_mask:0xf bank_mask:0x3
    v_add_f32_dpp v20, v17, v17 row_ror:8 row_mask:0xf bank_mask:0xc
    v_add_f32_dpp v21, v18, v18 row_ror:8 row_mask:0xf bank_mask:0x3
    v_add_f32_dpp v21, v19, v19 row_ror:8 row_mask:0xf bank_mask:0xc
    v_add_f32_dpp v22, v20, v20 row_half_mirror row_mask:0xf bank_mask:0x5
    s_nop 0
    v_add_f32_dpp v22, v21, v21 row_half_mirror row_mask:0xf bank_mask:0xa
    s_nop 1
    v_add_f32_dpp v22, v22, v22 quad_perm:[1,0,3,2] row_mask:0xf bank_mask:0xf
    s_nop 1
    v_add_f32_dpp v22, v22, v22 quad_perm:[2,3,0,1] row_mask:0xf bank_mask:0xf
    v_cvt_pk_bf16_f32 v22, v22, v22
    v_and_b32 v22, 0xffff0000, v22
    v_mul_f32 v22, 1035273459, v22
    v_cvt_pk_bf16_f32 v22, v22, v22
    v_and_b32 v22, 0xffff0000, v22
    v_max_f32 v23, v23, v22
    ds_write_b32 v12, v22 offset:960
    v_mov_b32 v150, v12
    s_mov_b32 s20, s8
    s_mov_b32 s21, s9
    s_mov_b32 s22, 0x400000
    s_mov_b32 s23, 0x20000
    s_mov_b32 s65, 0x7f800000
    v_mov_b32 v99, 4
    v_mov_b32 v96, 0
L_kl:
    s_add_u32 s66, s66, 32768
    s_cmp_eq_u32 s28, 1
    s_cselect_b32 s20, s12, s20
    s_cselect_b32 s21, s13, s21
    s_cselect_b32 s66, s33, s66
    s_cselect_b32 s65, s68, s65
    s_xor_b32 s26, s66, s89
    s_add_u32 s27, s26, 16384
    s_cmp_ge_u32 s66, s67
    s_cselect_b32 s27, 0x800000, s27
    s_cmp_le_u32 s28, 1
    s_cbranch_scc0 L_nke
    s_mov_b64 exec, 1
    ds_add_u32 v5, v99 offset:52
    s_mov_b64 exec, -1
L_nke:
    s_waitcnt vmcnt(5)
    v_dot2_f32_bf16 v16, v32, v0, 0
    v_dot2_f32_bf16 v16, v33, v1, v16
    v_dot2_f32_bf16 v16, v34, v2, v16
    v_dot2_f32_bf16 v16, v35, v3, v16
    buffer_load_dwordx4 v[32:35], v11, s[20:23], s26 offen offset:0 nt
    s_waitcnt vmcnt(5)
    v_dot2_f32_bf16 v17, v36, v0, 0
    v_dot2_f32_bf16 v17, v37, v1, v17
    v_dot2_f32_bf16 v17, v38, v2, v17
    v_dot2_f32_bf16 v17, v39, v3, v17
    buffer_load_dwordx4 v[36:39], v11, s[20:23], s26 offen offset:1024 nt
    s_waitcnt vmcnt(5)
    v_dot2_f32_bf16 v18, v40, v0, 0
    v_dot2_f32_bf16 v18, v41, v1, v18
    v_dot2_f32_bf16 v18, v42, v2, v18
    v_dot2_f32_bf16 v18, v43, v3, v18
    buffer_load_dwordx4 v[40:43], v11, s[20:23], s26 offen offset:2048 nt
    s_waitcnt vmcnt(5)
    v_dot2_f32_bf16 v19, v44, v0, 0
    v_dot2_f32_bf16 v19, v45, v1, v19
    v_dot2_f32_bf16 v19, v46, v2, v19
    v_dot2_f32_bf16 v19, v47, v3, v19
    buffer_load_dwordx4 v[44:47], v11, s[20:23], s26 offen offset:3072 nt
    v_add_f32_dpp v20, v16, v16 row_ror:8 row_mask:0xf bank_mask:0x3
    v_add_f32_dpp v20, v17, v17 row_ror:8 row_mask:0xf bank_mask:0xc
    v_add_f32_dpp v21, v18, v18 row_ror:8 row_mask:0xf bank_mask:0x3
    v_add_f32_dpp v21, v19, v19 row_ror:8 row_mask:0xf bank_mask:0xc
    v_add_f32_dpp v22, v20, v20 row_half_mirror row_mask:0xf bank_mask:0x5
    s_nop 0
    v_add_f32_dpp v22, v21, v21 row_half_mirror row_mask:0xf bank_mask:0xa
    s_nop 1
    v_add_f32_dpp v22, v22, v22 quad_perm:[1,0,3,2] row_mask:0xf bank_mask:0xf
    s_nop 1
    v_add_f32_dpp v22, v22, v22 quad_perm:[2,3,0,1] row_mask:0xf bank_mask:0xf
    v_cvt_pk_bf16_f32 v22, v22, v22
    v_and_b32 v22, 0xffff0000, v22
    v_mul_f32 v22, 1035273459, v22
    v_cvt_pk_bf16_f32 v22, v22, v22
    v_and_b32 v22, 0xffff0000, v22
    v_max_f32 v23, v23, v22
    ds_write_b32 v12, v22 offset:1024
    s_waitcnt vmcnt(5)
    v_dot2_f32_bf16 v16, v48, v0, 0
    v_dot2_f32_bf16 v16, v49, v1, v16
    v_dot2_f32_bf16 v16, v50, v2, v16
    v_dot2_f32_bf16 v16, v51, v3, v16
    buffer_load_dwordx4 v[48:51], v11, s[20:23], s27 offen offset:0 nt
    s_waitcnt vmcnt(5)
    v_dot2_f32_bf16 v17, v52, v0, 0
    v_dot2_f32_bf16 v17, v53, v1, v17
    v_dot2_f32_bf16 v17, v54, v2, v17
    v_dot2_f32_bf16 v17, v55, v3, v17
    buffer_load_dwordx4 v[52:55], v11, s[20:23], s27 offen offset:1024 nt
    s_waitcnt vmcnt(5)
    v_dot2_f32_bf16 v18, v56, v0, 0
    v_dot2_f32_bf16 v18, v57, v1, v18
    v_dot2_f32_bf16 v18, v58, v2, v18
    v_dot2_f32_bf16 v18, v59, v3, v18
    buffer_load_dwordx4 v[56:59], v11, s[20:23], s27 offen offset:2048 nt
    s_waitcnt vmcnt(5)
    v_dot2_f32_bf16 v19, v60, v0, 0
    v_dot2_f32_bf16 v19, v61, v1, v19
    v_dot2_f32_bf16 v19, v62, v2, v19
    v_dot2_f32_bf16 v19, v63, v3, v19
    buffer_load_dwordx4 v[60:63], v11, s[20:23], s27 offen offset:3072 nt
    v_add_f32_dpp v20, v16, v16 row_ror:8 row_mask:0xf bank_mask:0x3
    v_add_f32_dpp v20, v17, v17 row_ror:8 row_mask:0xf bank_mask:0xc
    v_add_f32_dpp v21, v18, v18 row_ror:8 row_mask:0xf bank_mask:0x3
    v_add_f32_dpp v21, v19, v19 row_ror:8 row_mask:0xf bank_mask:0xc
    v_add_f32_dpp v22, v20, v20 row_half_mirror row_mask:0xf bank_mask:0x5
    s_nop 0
    v_add_f32_dpp v22, v21, v21 row_half_mirror row_mask:0xf bank_mask:0xa
    s_nop 1
    v_add_f32_dpp v22, v22, v22 quad_perm:[1,0,3,2] row_mask:0xf bank_mask:0xf
    s_nop 1
    v_add_f32_dpp v22, v22, v22 quad_perm:[2,3,0,1] row_mask:0xf bank_mask:0xf
    v_cvt_pk_bf16_f32 v22, v22, v22
    v_and_b32 v22, 0xffff0000, v22
    v_mul_f32 v22, 1035273459, v22
    v_cvt_pk_bf16_f32 v22, v22, v22
    v_and_b32 v22, 0xffff0000, v22
    v_min_f32 v22, s65, v22
    v_max_f32 v23, v23, v22
    ds_write_b32 v12, v22 offset:1088
    v_add_u32 v12, 128, v12
    s_sub_u32 s28, s28, 1
    s_cmp_lg_u32 s28, 0
    s_cbranch_scc1 L_kl
    v_max_f32_dpp v16, v23, v23 row_ror:8 row_mask:0xf bank_mask:0xf
    s_nop 1
    v_max_f32_dpp v16, v16, v16 row_ror:4 row_mask:0xf bank_mask:0xf
    v_mov_b32 v17, v16
    s_nop 1
    v_permlane16_swap_b32 v16, v17
    v_max_f32 v16, v16, v17
    v_mov_b32 v17, v16
    s_nop 1
    v_permlane32_swap_b32 v16, v17
    v_max_f32 v16, v16, v17
    v_mul_f32 v17, v4, v16
    v_sub_f32 v17, 0, v17
    v_readfirstlane_b32 s24, v16
    v_readfirstlane_b32 s25, v17
    v_mov_b32 v12, 0
    v_mov_b32 v13, 0
    v_mov_b32 v14, 0
    v_mov_b32 v15, 0
    v_lshrrev_b32 v142, 1, v11
    s_lshl_b32 s6, s3, 9
    v_add_u32 v143, s6, v142
    s_lshl_b32 s6, s3, 3
    v_mov_b32 v144, s6
    v_mov_b32 v145, 1
    v_lshrrev_b32 v136, 4, v142
    v_add_u32 v136, s64, v136
    v_mov_b32 v147, s64
    v_mov_b32 v149, s64
    s_mul_i32 s32, s2, 640
    s_add_u32 s32, s32, 393216
    s_mov_b32 s35, 2155172
    v_mov_b32 v16, 44
Lw_7:
    s_sub_u32 s35, s35, 1
    s_cbranch_scc1 Lx_8
    ds_read_b32 v17, v16
    s_waitcnt lgkmcnt(0)
    v_readfirstlane_b32 s34, v17
    s_nop 0
    s_cmp_ge_u32 s34, s95
    s_cbranch_scc1 Lx_8
    s_sleep 2
    s_branch Lw_7
Lx_8:
L_vl:
    ds_read2_b32 v[152:153], v150 offset0:0 offset1:16
    s_add_u32 s66, s66, 32768
    s_xor_b32 s26, s66, s89
    s_add_u32 s27, s26, 16384
    s_cmp_ge_u32 s66, s67
    s_cselect_b32 s27, 0x800000, s27
    s_cmp_eq_u32 s29, 1
    s_cbranch_scc1 L_vlast
    s_mov_b64 exec, 1
    ds_add_u32 v5, v99 offset:20
    s_mov_b64 exec, -1
    s_waitcnt lgkmcnt(1)
L_vgo:
    v_fma_f32 v23, v152, v4, s25
    v_exp_f32 v23, v23
    s_nop 0
    v_add_f32 v10, v10, v23
    v_cvt_pk_bf16_f32 v23, v23, v23
    s_nop 1
    v_and_b32_dpp v24, v23, v6 row_newbcast:0 row_mask:0xf bank_mask:0xf
    v_and_b32_dpp v25, v23, v7 row_newbcast:0 row_mask:0xf bank_mask:0xf
    v_and_b32_dpp v26, v23, v8 row_newbcast:0 row_mask:0xf bank_mask:0xf
    v_and_b32_dpp v27, v23, v9 row_newbcast:0 row_mask:0xf bank_mask:0xf
    v_and_b32_dpp v28, v23, v6 row_newbcast:8 row_mask:0xf bank_mask:0xf
    v_and_b32_dpp v29, v23, v7 row_newbcast:8 row_mask:0xf bank_mask:0xf
    v_and_b32_dpp v30, v23, v8 row_newbcast:8 row_mask:0xf bank_mask:0xf
    v_and_b32_dpp v31, v23, v9 row_newbcast:8 row_mask:0xf bank_mask:0xf
    s_waitcnt vmcnt(5)
    v_mfma_f32_16x16x32_bf16 v[12:15], v[32:35], v[24:27], v[12:15]
    buffer_load_dwordx4 v[32:35], v11, s[20:23], s26 offen offset:0 nt
    v_and_b32_dpp v24, v23, v6 row_newbcast:4 row_mask:0xf bank_mask:0xf
    v_and_b32_dpp v25, v23, v7 row_newbcast:4 row_mask:0xf bank_mask:0xf
    v_and_b32_dpp v26, v23, v8 row_newbcast:4 row_mask:0xf bank_mask:0xf
    v_and_b32_dpp v27, v23, v9 row_newbcast:4 row_mask:0xf bank_mask:0xf
    s_waitcnt vmcnt(5)
    v_mfma_f32_16x16x32_bf16 v[12:15], v[36:39], v[28:31], v[12:15]
    buffer_load_dwordx4 v[36:39], v11, s[20:23], s26 offen offset:1024 nt
    v_and_b32_dpp v28, v23, v6 row_newbcast:12 row_mask:0xf bank_mask:0xf
    v_and_b32_dpp v29, v23, v7 row_newbcast:12 row_mask:0xf bank_mask:0xf
    v_and_b32_dpp v30, v23, v8 row_newbcast:12 row_mask:0xf bank_mask:0xf
    v_and_b32_dpp v31, v23, v9 row_newbcast:12 row_mask:0xf bank_mask:0xf
    s_waitcnt vmcnt(5)
    v_mfma_f32_16x16x32_bf16 v[12:15], v[40:43], v[24:27], v[12:15]
    buffer_load_dwordx4 v[40:43], v11, s[20:23], s26 offen offset:2048 nt
    s_waitcnt vmcnt(5)
    v_mfma_f32_16x16x32_bf16 v[12:15], v[44:47], v[28:31], v[12:15]
    buffer_load_dwordx4 v[44:47], v11, s[20:23], s26 offen offset:3072 nt
    v_fma_f32 v23, v153, v4, s25
    v_exp_f32 v23, v23
    s_nop 0
    v_add_f32 v10, v10, v23
    v_cvt_pk_bf16_f32 v23, v23, v23
    s_nop 1
    v_and_b32_dpp v24, v23, v6 row_newbcast:0 row_mask:0xf bank_mask:0xf
    v_and_b32_dpp v25, v23, v7 row_newbcast:0 row_mask:0xf bank_mask:0xf
    v_and_b32_dpp v26, v23, v8 row_newbcast:0 row_mask:0xf bank_mask:0xf
    v_and_b32_dpp v27, v23, v9 row_newbcast:0 row_mask:0xf bank_mask:0xf
    v_and_b32_dpp v28, v23, v6 row_newbcast:8 row_mask:0xf bank_mask:0xf
    v_and_b32_dpp v29, v23, v7 row_newbcast:8 row_mask:0xf bank_mask:0xf
    v_and_b32_dpp v30, v23, v8 row_newbcast:8 row_mask:0xf bank_mask:0xf
    v_and_b32_dpp v31, v23, v9 row_newbcast:8 row_mask:0xf bank_mask:0xf
    s_waitcnt vmcnt(5)
    v_mfma_f32_16x16x32_bf16 v[12:15], v[48:51], v[24:27], v[12:15]
    buffer_load_dwordx4 v[48:51], v11, s[12:15], s27 offen offset:0 nt
    v_and_b32_dpp v24, v23, v6 row_newbcast:4 row_mask:0xf bank_mask:0xf
    v_and_b32_dpp v25, v23, v7 row_newbcast:4 row_mask:0xf bank_mask:0xf
    v_and_b32_dpp v26, v23, v8 row_newbcast:4 row_mask:0xf bank_mask:0xf
    v_and_b32_dpp v27, v23, v9 row_newbcast:4 row_mask:0xf bank_mask:0xf
    s_waitcnt vmcnt(5)
    v_mfma_f32_16x16x32_bf16 v[12:15], v[52:55], v[28:31], v[12:15]
    buffer_load_dwordx4 v[52:55], v11, s[12:15], s27 offen offset:1024 nt
    v_and_b32_dpp v28, v23, v6 row_newbcast:12 row_mask:0xf bank_mask:0xf
    v_and_b32_dpp v29, v23, v7 row_newbcast:12 row_mask:0xf bank_mask:0xf
    v_and_b32_dpp v30, v23, v8 row_newbcast:12 row_mask:0xf bank_mask:0xf
    v_and_b32_dpp v31, v23, v9 row_newbcast:12 row_mask:0xf bank_mask:0xf
    s_waitcnt vmcnt(5)
    v_mfma_f32_16x16x32_bf16 v[12:15], v[56:59], v[24:27], v[12:15]
    buffer_load_dwordx4 v[56:59], v11, s[12:15], s27 offen offset:2048 nt
    s_waitcnt vmcnt(5)
    v_mfma_f32_16x16x32_bf16 v[12:15], v[60:63], v[28:31], v[12:15]
    buffer_load_dwordx4 v[60:63], v11, s[12:15], s27 offen offset:3072 nt
    v_add_u32 v150, 128, v150
    s_sub_u32 s29, s29, 1
    s_cmp_lg_u32 s29, 0
    s_cbranch_scc1 L_vl
    s_cmp_lt_u32 s26, 0x400000
    s_cbranch_scc0 L_nopool
    s_mov_b64 exec, 1
    ds_add_rtn_u32 v96, v5, v99 offset:16
    s_mov_b64 exec, -1
    s_waitcnt lgkmcnt(0)
    s_mov_b64 exec, 1
    ds_read_b32 v97, v96 offset:96
    s_mov_b64 exec, -1
    s_branch L_dyn
L_dgo:
    s_waitcnt vmcnt(7)
    v_dot2_f32_bf16 v16, v32, v0, 0
    v_dot2_f32_bf16 v16, v33, v1, v16
    v_dot2_f32_bf16 v16, v34, v2, v16
    v_dot2_f32_bf16 v16, v35, v3, v16
    buffer_load_dwordx4 v[32:35], v11, s[8:11], s26 offen offset:0 nt
    s_waitcnt vmcnt(7)
    v_dot2_f32_bf16 v17, v36, v0, 0
    v_dot2_f32_bf16 v17, v37, v1, v17
    v_dot2_f32_bf16 v17, v38, v2, v17
    v_dot2_f32_bf16 v17, v39, v3, v17
    buffer_load_dwordx4 v[36:39], v11, s[8:11], s26 offen offset:1024 nt
    s_waitcnt vmcnt(7)
    v_dot2_f32_bf16 v18, v40, v0, 0
    v_dot2_f32_bf16 v18, v41, v1, v18
    v_dot2_f32_bf16 v18, v42, v2, v18
    v_dot2_f32_bf16 v18, v43, v3, v18
    buffer_load_dwordx4 v[40:43], v11, s[8:11], s26 offen offset:2048 nt
    s_waitcnt vmcnt(7)
    v_dot2_f32_bf16 v19, v44, v0, 0
    v_dot2_f32_bf16 v19, v45, v1, v19
    v_dot2_f32_bf16 v19, v46, v2, v19
    v_dot2_f32_bf16 v19, v47, v3, v19
    buffer_load_dwordx4 v[44:47], v11, s[8:11], s26 offen offset:3072 nt
    v_add_f32_dpp v20, v16, v16 row_ror:8 row_mask:0xf bank_mask:0x3
    v_add_f32_dpp v20, v17, v17 row_ror:8 row_mask:0xf bank_mask:0xc
    v_add_f32_dpp v21, v18, v18 row_ror:8 row_mask:0xf bank_mask:0x3
    v_add_f32_dpp v21, v19, v19 row_ror:8 row_mask:0xf bank_mask:0xc
    v_add_f32_dpp v22, v20, v20 row_half_mirror row_mask:0xf bank_mask:0x5
    s_nop 0
    v_add_f32_dpp v22, v21, v21 row_half_mirror row_mask:0xf bank_mask:0xa
    s_nop 1
    v_add_f32_dpp v22, v22, v22 quad_perm:[1,0,3,2] row_mask:0xf bank_mask:0xf
    s_nop 1
    v_add_f32_dpp v22, v22, v22 quad_perm:[2,3,0,1] row_mask:0xf bank_mask:0xf
    v_cvt_pk_bf16_f32 v22, v22, v22
    v_and_b32 v22, 0xffff0000, v22
    v_mul_f32 v22, 1035273459, v22
    v_cvt_pk_bf16_f32 v22, v22, v22
    v_and_b32 v22, 0xffff0000, v22
    v_cmp_lt_f32 vcc, s24, v22
    s_cbranch_vccnz Ltr_9
Lbk_10:
    v_fma_f32 v23, v22, v4, s25
    v_exp_f32 v23, v23
    s_nop 0
    v_add_f32 v10, v10, v23
    v_cvt_pk_bf16_f32 v23, v23, v23
    s_nop 1
    v_and_b32_dpp v24, v23, v6 row_newbcast:0 row_mask:0xf bank_mask:0xf
    v_and_b32_dpp v25, v23, v7 row_newbcast:0 row_mask:0xf bank_mask:0xf
    v_and_b32_dpp v26, v23, v8 row_newbcast:0 row_mask:0xf bank_mask:0xf
    v_and_b32_dpp v27, v23, v9 row_newbcast:0 row_mask:0xf bank_mask:0xf
    v_and_b32_dpp v28, v23, v6 row_newbcast:8 row_mask:0xf bank_mask:0xf
    v_and_b32_dpp v29, v23, v7 row_newbcast:8 row_mask:0xf bank_mask:0xf
    v_and_b32_dpp v30, v23, v8 row_newbcast:8 row_mask:0xf bank_mask:0xf
    v_and_b32_dpp v31, v23, v9 row_newbcast:8 row_mask:0xf bank_mask:0xf
    s_waitcnt vmcnt(7)
    v_mfma_f32_16x16x32_bf16 v[12:15], v[48:51], v[24:27], v[12:15]
    buffer_load_dwordx4 v[48:51], v11, s[12:15], s26 offen offset:0 nt
    v_and_b32_dpp v24, v23, v6 row_newbcast:4 row_mask:0xf bank_mask:0xf
    v_and_b32_dpp v25, v23, v7 row_newbcast:4 row_mask:0xf bank_mask:0xf
    v_and_b32_dpp v26, v23, v8 row_newbcast:4 row_mask:0xf bank_mask:0xf
    v_and_b32_dpp v27, v23, v9 row_newbcast:4 row_mask:0xf bank_mask:0xf
    s_waitcnt vmcnt(7)
    v_mfma_f32_16x16x32_bf16 v[12:15], v[52:55], v[28:31], v[12:15]
    buffer_load_dwordx4 v[52:55], v11, s[12:15], s26 offen offset:1024 nt
    s_mov_b64 exec, 1
    ds_add_rtn_u32 v96, v5, v99 offset:16
    s_mov_b64 exec, -1
    v_and_b32_dpp v28, v23, v6 row_newbcast:12 row_mask:0xf bank_mask:0xf
    v_and_b32_dpp v29, v23, v7 row_newbcast:12 row_mask:0xf bank_mask:0xf
    v_and_b32_dpp v30, v23, v8 row_newbcast:12 row_mask:0xf bank_mask:0xf
    v_and_b32_dpp v31, v23, v9 row_newbcast:12 row_mask:0xf bank_mask:0xf
    s_waitcnt vmcnt(7)
    v_mfma_f32_16x16x32_bf16 v[12:15], v[56:59], v[24:27], v[12:15]
    buffer_load_dwordx4 v[56:59], v11, s[12:15], s26 offen offset:2048 nt
    s_waitcnt vmcnt(7)
    v_mfma_f32_16x16x32_bf16 v[12:15], v[60:63], v[28:31], v[12:15]
    buffer_load_dwordx4 v[60:63], v11, s[12:15], s26 offen offset:3072 nt
    s_waitcnt lgkmcnt(0)
    s_mov_b64 exec, 1
    ds_read_b32 v97, v96 offset:96
    s_mov_b64 exec, -1
L_dyn:
    s_mov_b32 s35, 2000000
L_dre:
    s_waitcnt lgkmcnt(0)
    v_readfirstlane_b32 s26, v97
    s_nop 0
    s_cmp_eq_u32 s26, 0
    s_cbranch_scc1 L_dwait
    s_cmp_lt_u32 s26, 0x400000
    s_cbranch_scc1 L_dgo
L_fin:
    s_waitcnt vmcnt(7)
    v_dot2_f32_bf16 v16, v32, v0, 0
    v_dot2_f32_bf16 v16, v33, v1, v16
    v_dot2_f32_bf16 v16, v34, v2, v16
    v_dot2_f32_bf16 v16, v35, v3, v16
    s_waitcnt vmcnt(6)
    v_dot2_f32_bf16 v17, v36, v0, 0
    v_dot2_f32_bf16 v17, v37, v1, v17
    v_dot2_f32_bf16 v17, v38, v2, v17
    v_dot2_f32_bf16 v17, v39, v3, v17
    s_waitcnt vmcnt(5)
    v_dot2_f32_bf16 v18, v40, v0, 0
    v_dot2_f32_bf16 v18, v41, v1, v18
    v_dot2_f32_bf16 v18, v42, v2, v18
    v_dot2_f32_bf16 v18, v43, v3, v18
    s_waitcnt vmcnt(4)
    v_dot2_f32_bf16 v19, v44, v0, 0
    v_dot2_f32_bf16 v19, v45, v1, v19
    v_dot2_f32_bf16 v19, v46, v2, v19
    v_dot2_f32_bf16 v19, v47, v3, v19
    v_add_f32_dpp v20, v16, v16 row_ror:8 row_mask:0xf bank_mask:0x3
    v_add_f32_dpp v20, v17, v17 row_ror:8 row_mask:0xf bank_mask:0xc
    v_add_f32_dpp v21, v18, v18 row_ror:8 row_mask:0xf bank_mask:0x3
    v_add_f32_dpp v21, v19, v19 row_ror:8 row_mask:0xf bank_mask:0xc
    v_add_f32_dpp v22, v20, v20 row_half_mirror row_mask:0xf bank_mask:0x5
    s_nop 0
    v_add_f32_dpp v22, v21, v21 row_half_mirror row_mask:0xf bank_mask:0xa
    s_nop 1
    v_add_f32_dpp v22, v22, v22 quad_perm:[1,0,3,2] row_mask:0xf bank_mask:0xf
    s_nop 1
    v_add_f32_dpp v22, v22, v22 quad_perm:[2,3,0,1] row_mask:0xf bank_mask:0xf
    v_cvt_pk_bf16_f32 v22, v22, v22
    v_and_b32 v22, 0xffff0000, v22
    v_mul_f32 v22, 1035273459, v22
    v_cvt_pk_bf16_f32 v22, v22, v22
    v_and_b32 v22, 0xffff0000, v22
    v_cmp_lt_f32 vcc, s24, v22
    s_cbranch_vccnz Ltr_11
Lbk_12:
    v_fma_f32 v23, v22, v4, s25
    v_exp_f32 v23, v23
    s_nop 0
    v_add_f32 v10, v10, v23
    v_cvt_pk_bf16_f32 v23, v23, v23
    s_nop 0
    v_add_f32_dpp v21, v10, v10 row_ror:8 row_mask:0xf bank_mask:0xf
    v_sub_f32 v20, 0, s25
    s_nop 0
    v_add_f32_dpp v21, v21, v21 row_ror:4 row_mask:0xf bank_mask:0xf
    v_mov_b32 v16, v21
    s_nop 1
    v_permlane16_swap_b32 v21, v16
    v_add_f32 v21, v21, v16
    v_mov_b32 v16, v21
    s_nop 1
    v_permlane32_swap_b32 v21, v16
    v_add_f32 v21, v21, v16
    ds_write_b64 v144, v[20:21] offset:4608
    v_and_b32_dpp v24, v23, v6 row_newbcast:0 row_mask:0xf bank_mask:0xf
    v_and_b32_dpp v25, v23, v7 row_newbcast:0 row_mask:0xf bank_mask:0xf
    v_and_b32_dpp v26, v23, v8 row_newbcast:0 row_mask:0xf bank_mask:0xf
    v_and_b32_dpp v27, v23, v9 row_newbcast:0 row_mask:0xf bank_mask:0xf
    v_and_b32_dpp v28, v23, v6 row_newbcast:8 row_mask:0xf bank_mask:0xf
    v_and_b32_dpp v29, v23, v7 row_newbcast:8 row_mask:0xf bank_mask:0xf
    v_and_b32_dpp v30, v23, v8 row_newbcast:8 row_mask:0xf bank_mask:0xf
    v_and_b32_dpp v31, v23, v9 row_newbcast:8 row_mask:0xf bank_mask:0xf
    s_waitcnt vmcnt(3)
    v_mfma_f32_16x16x32_bf16 v[12:15], v[48:51], v[24:27], v[12:15]
    v_and_b32_dpp v24, v23, v6 row_newbcast:4 row_mask:0xf bank_mask:0xf
    v_and_b32_dpp v25, v23, v7 row_newbcast:4 row_mask:0xf bank_mask:0xf
    v_and_b32_dpp v26, v23, v8 row_newbcast:4 row_mask:0xf bank_mask:0xf
    v_and_b32_dpp v27, v23, v9 row_newbcast:4 row_mask:0xf bank_mask:0xf
    s_waitcnt vmcnt(2)
    v_mfma_f32_16x16x32_bf16 v[12:15], v[52:55], v[28:31], v[12:15]
    v_and_b32_dpp v28, v23, v6 row_newbcast:12 row_mask:0xf bank_mask:0xf
    v_and_b32_dpp v29, v23, v7 row_newbcast:12 row_mask:0xf bank_mask:0xf
    v_and_b32_dpp v30, v23, v8 row_newbcast:12 row_mask:0xf bank_mask:0xf
    v_and_b32_dpp v31, v23, v9 row_newbcast:12 row_mask:0xf bank_mask:0xf
    s_waitcnt vmcnt(1)
    v_mfma_f32_16x16x32_bf16 v[12:15], v[56:59], v[24:27], v[12:15]
    s_waitcnt vmcnt(0)
    v_mfma_f32_16x16x32_bf16 v[12:15], v[60:63], v[28:31], v[12:15]
L_pure:
    s_nop 7
    v_mov_b32_dpp v12, v14 row_shr:8 row_mask:0xf bank_mask:0xc
    v_mov_b32_dpp v13, v15 row_shr:8 row_mask:0xf bank_mask:0xc
    ds_write_b64 v143, v[12:13] offset:2048
    s_mov_b64 exec, 1
    ds_add_rtn_u32 v16, v5, v145 offset:4
    s_mov_b64 exec, -1
    ds_read_b128 v[24:27], v5 offset:4608
    ds_read_b128 v[28:31], v5 offset:4624
    ds_read_b64 v[128:129], v142 offset:2048
    ds_read_b64 v[130:131], v142 offset:2560
    ds_read_b64 v[132:133], v142 offset:3072
    ds_read_b64 v[134:135], v142 offset:3584
    s_waitcnt lgkmcnt(4)
    v_max3_f32 v146, v24, v26, v28
    v_readfirstlane_b32 s28, v16
    v_max_f32 v146, v146, v30
    v_sub_f32 v24, v24, v146
    v_sub_f32 v26, v26, v146
    v_sub_f32 v28, v28, v146
    v_sub_f32 v30, v30, v146
    v_exp_f32 v24, v24
    v_exp_f32 v26, v26
    v_exp_f32 v28, v28
    v_exp_f32 v30, v30
    s_waitcnt lgkmcnt(0)
    v_pk_mul_f32 v[22:23], v[128:129], v[24:25] op_sel_hi:[1,0]
    s_nop 0
    v_pk_fma_f32 v[22:23], v[130:131], v[26:27], v[22:23] op_sel_hi:[1,0,1]
    s_nop 0
    v_pk_fma_f32 v[22:23], v[132:133], v[28:29], v[22:23] op_sel_hi:[1,0,1]
    s_nop 0
    v_pk_fma_f32 v[22:23], v[134:135], v[30:31], v[22:23] op_sel_hi:[1,0,1]
    v_mul_f32 v148, v24, v25
    v_bfi_b32 v22, s69, v136, v22
    v_bfi_b32 v23, s69, v136, v23
    s_cmp_eq_u32 s28, 3
    s_cbranch_scc0 L_sdone
    buffer_store_dwordx2 v[22:23], v142, s[16:19], s32 offen sc1
    v_fmac_f32 v148, v26, v27
    v_fmac_f32 v148, v28, v29
    v_fmac_f32 v148, v30, v31
    s_mov_b64 exec, 1
    buffer_store_dwordx4 v[146:149], v5, s[16:19], s32 offen offset:512 sc1
    ds_add_u32 v5, v145 offset:4
    s_mov_b64 exec, -1
L_sdone:
    s_mov_b64 exec, -1
    s_cmp_eq_u32 s5, 7
    s_cbranch_scc0 L_end
    s_cmp_ge_u32 s4, 5
    s_cbranch_scc1 L_dwave
    s_endpgm
L_nopool:
    v_add_f32_dpp v21, v10, v10 row_ror:8 row_mask:0xf bank_mask:0xf
    v_sub_f32 v20, 0, s25
    s_nop 0
    v_add_f32_dpp v21, v21, v21 row_ror:4 row_mask:0xf bank_mask:0xf
    v_mov_b32 v16, v21
    s_nop 1
    v_permlane16_swap_b32 v21, v16
    v_add_f32 v21, v21, v16
    v_mov_b32 v16, v21
    s_nop 1
    v_permlane32_swap_b32 v21, v16
    v_add_f32 v21, v21, v16
    ds_write_b64 v144, v[20:21] offset:4608
    s_branch L_pure
L_vlast:
    s_mov_b64 exec, 1
    ds_add_rtn_u32 v96, v5, v99 offset:16
    s_mov_b64 exec, -1
    s_waitcnt lgkmcnt(0)
    s_mov_b64 exec, 1
    ds_read_b32 v97, v96 offset:96
    s_mov_b64 exec, -1
    s_mov_b32 s35, 2000000
L_vre:
    s_waitcnt lgkmcnt(0)
    v_readfirstlane_b32 s26, v97
    s_mov_b32 s20, s8
    s_mov_b32 s21, s9
    s_and_b32 s26, s26, -2
    s_mov_b32 s27, s26
    s_cmp_lg_u32 s26, 0
    s_cbranch_scc1 L_vgo
    s_mov_b32 s26, 0x800000
    s_mov_b32 s27, s26
    s_sub_u32 s35, s35, 1
    s_cbranch_scc1 L_vgo
    s_sleep 1
    s_mov_b64 exec, 1
    ds_read_b32 v97, v96 offset:96
    s_mov_b64 exec, -1
    s_branch L_vre
L_dwait:
    s_sub_u32 s35, s35, 1
    s_cbranch_scc1 L_fin
    s_sleep 1
    s_mov_b64 exec, 1
    ds_read_b32 v97, v96 offset:96
    s_mov_b64 exec, -1
    s_branch L_dre
Ltr_9:
    s_call_b64 s[30:31], L_rescale
    s_branch Lbk_10
Ltr_11:
    s_call_b64 s[30:31], L_rescale
    s_branch Lbk_12
L_rescale:
    s_nop 7
    v_max_f32_dpp v16, v22, v22 row_ror:8 row_mask:0xf bank_mask:0xf
    s_nop 1
    v_max_f32_dpp v16, v16, v16 row_ror:4 row_mask:0xf bank_mask:0xf
    v_mov_b32 v17, v16
    s_nop 1
    v_permlane16_swap_b32 v16, v17
    v_max_f32 v16, v16, v17
    v_mov_b32 v17, v16
    s_nop 1
    v_permlane32_swap_b32 v16, v17
    v_max_f32 v16, v16, v17
    v_mul_f32 v17, v4, v16
    v_add_f32 v18, s25, v17
    v_exp_f32 v18, -v18
    v_sub_f32 v17, 0, v17
    v_readfirstlane_b32 s24, v16
    v_readfirstlane_b32 s25, v17
    v_mul_f32 v12, v12, v18
    v_mul_f32 v13, v13, v18
    v_mul_f32 v14, v14, v18
    v_mul_f32 v15, v15, v18
    v_mul_f32 v10, v10, v18
    s_nop 1
    s_setpc_b64 s[30:31]
L_fetch:
    s_mul_i32 s6, s4, 4352
    s_add_u32 s6, s6, 1048576
    s_add_u32 s92, s62, s6
    s_addc_u32 s93, s63, 0
    s_mov_b32 s7, 0
    v_mov_b32 v32, 0
    s_mov_b32 s35, 2000000
L_f0:
    s_sub_u32 s35, s35, 1
    s_cbranch_scc1 L_fx
    ds_read_b64 v[34:35], v32 offset:16
    s_add_u32 s6, s7, s96
    s_waitcnt lgkmcnt(0)
    v_add_u32 v33, v34, v35
    s_nop 0
    v_readfirstlane_b32 s34, v33
    s_nop 0
    s_add_u32 s34, s34, 24
    s_cmp_lt_u32 s6, s34
    s_cbranch_scc1 L_fl
    s_sleep 4
    s_branch L_f0
L_fl:
    s_sub_u32 s35, s35, 1
    s_cbranch_scc1 L_fx
    s_load_dword s89, s[92:93], 0 glc
    s_waitcnt lgkmcnt(0)
    s_add_u32 s34, s89, s95
    s_cmp_ge_u32 s34, s97
    s_cbranch_scc1 L_fx
    ds_read_b64 v[34:35], v32 offset:16
    s_waitcnt lgkmcnt(0)
    v_add_u32 v33, v34, v35
    s_nop 0
    v_readfirstlane_b32 s34, v33
    s_nop 0
    s_add_u32 s34, s34, 8
    s_cmp_lt_u32 s6, s34
    s_cbranch_scc0 L_f0
    s_sub_u32 s88, s97, s89
    s_lshr_b32 s88, s88, 3
    s_max_u32 s88, s88, 1
    s_min_u32 s88, s88, 12
    s_mov_b32 s6, s88
    s_atomic_add s6, s[92:93], 0 glc
    v_lshl_add_u32 v34, v1, 2, s7
    s_waitcnt lgkmcnt(0)
    s_cmp_ge_u32 s6, s97
    s_cbranch_scc1 L_fx
    v_add_u32 v33, s6, v1
    v_and_b32 v35, 0xfc, v33
    ds_read_b32 v35, v35 offset:1792
    v_and_b32 v36, 3, v33
    v_mov_b32 v37, 0x800000
    v_cmp_gt_u32 vcc, s97, v33
    s_waitcnt lgkmcnt(0)
    v_lshl_add_u32 v35, v36, 12, v35
    v_cndmask_b32 v35, v37, v35, vcc
    v_cmp_gt_u32 vcc, s88, v1
    s_nop 0
    s_and_b64 exec, exec, vcc
    ds_write_b32 v34, v35 offset:96
    s_mov_b64 exec, -1
    s_lshl_b32 s34, s88, 2
    s_add_u32 s7, s7, s34
    s_add_u32 s89, s6, s88
    s_cmp_lt_u32 s89, s97
    s_cbranch_scc1 L_f0
L_fx:
    v_and_b32 v33, 15, v1
    v_lshl_add_u32 v33, v33, 2, s7
    v_mov_b32 v34, 0x800000
    ds_write_b32 v33, v34 offset:96
    v_mov_b32 v34, s7
    ds_write_b32 v32, v34 offset:12
    s_waitcnt lgkmcnt(0)
    s_setpc_b64 s[30:31]
L_t0:
    s_waitcnt lgkmcnt(0)
    s_mul_i32 s64, s64, 1664525
    s_add_u32 s64, s64, 1013904223
    s_movk_i32 s69, 0xff
L_tail:
    s_waitcnt vmcnt(0)
    v_and_b32 v4, 3, v2
    v_lshrrev_b32 v5, 2, v2
    s_cmp_eq_u32 s5, 7
    s_cbranch_scc0 L_nf7
    s_cmp_ge_u32 s4, 5
    s_cbranch_scc1 L_ffn
L_nf7:
    s_lshl_b32 s6, s5, 5
    s_add_u32 s66, s6, s4
    s_cmp_lt_u32 s5, 2
    s_cbranch_scc1 L_w
    s_cmp_eq_u32 s5, 2
    s_cbranch_scc0 L_norole
    s_add_u32 s6, s4, 11
    s_and_b32 s6, s6, 31
    s_add_u32 s66, s6, 64
    s_cmp_lt_u32 s6, 16
    s_cbranch_scc1 L_w
L_norole:
    s_cmp_eq_u32 s3, 0
    s_cbranch_scc0 Lnf_13
    s_mov_b32 s95, 0
    s_call_b64 s[30:31], L_fetch
Lnf_13:
    s_endpgm
L_w:
    s_mul_i32 s33, s66, 205
    s_lshr_b32 s33, s33, 11
    s_mul_i32 s32, s33, 10
    s_sub_u32 s32, s66, s32
    s_mov_b32 s8, s44
    s_mov_b32 s9, s45
    s_mov_b32 s10, 5242880
    s_mov_b32 s11, 0x20000
    v_lshrrev_b32 v32, 3, v1
    v_mul_u32_u24 v32, 1280, v32
    v_and_b32 v33, 7, v1
    v_and_b32 v34, 1, v3
    v_lshlrev_b32 v34, 1, v34
    v_xor_b32 v33, v33, v34
    v_lshl_add_u32 v40, v33, 4, v32
    v_xor_b32 v33, 4, v33
    v_lshl_add_u32 v41, v33, 4, v32
    s_cmp_ge_u32 s3, 2
    s_cbranch_scc0 L_w1
    s_mov_b32 s35, 880281
    v_mov_b32 v32, 52
Lw_14:
    s_sub_u32 s35, s35, 1
    s_cbranch_scc1 Lx_15
    ds_read_b32 v33, v32
    s_waitcnt lgkmcnt(0)
    v_readfirstlane_b32 s34, v33
    s_nop 0
    s_cmp_ge_u32 s34, 1
    s_cbranch_scc1 Lx_15
    s_sleep 8
    s_branch Lw_14
Lx_15:
    s_sub_u32 s7, s3, 2
    s_mul_i32 s6, s33, 655360
    s_lshl_b32 s24, s32, 7
    s_add_u32 s24, s24, s6
    s_mul_i32 s6, s7, 327680
    s_add_u32 s24, s24, s6
    s_lshl_b32 s25, s7, 15
    s_add_u32 s25, s25, 17408
    s_mov_b32 s28, 16
L_dw:
    s_mov_b32 m0, s25
    s_add_u32 s25, s25, 1024
    buffer_load_dwordx4 v40, s[8:11], s24 offen nt lds
    s_add_u32 s24, s24, 10240
    s_mov_b32 m0, s25
    s_add_u32 s25, s25, 1024
    buffer_load_dwordx4 v41, s[8:11], s24 offen nt lds
    s_add_u32 s24, s24, 10240
    s_sub_u32 s28, s28, 1
    s_cmp_lg_u32 s28, 0
    s_cbranch_scc1 L_dw
    s_mov_b64 exec, 1
    v_mov_b32 v32, 44
    v_mov_b32 v33, 1
    ds_add_u32 v32, v33
    s_mov_b64 exec, -1
    s_waitcnt vmcnt(0)
    s_mov_b64 exec, 1
    v_mov_b32 v32, 8
    v_mov_b32 v33, 1
    ds_add_u32 v32, v33
    s_mov_b64 exec, -1
L_w1:
    v_lshl_add_u32 v42, v3, 3, v5
    v_lshlrev_b32 v42, 7, v42
    v_lshl_add_u32 v42, v4, 3, v42
    v_lshrrev_b32 v33, 1, v5
    v_and_b32 v34, 1, v3
    v_lshl_add_u32 v33, v34, 1, v33
    v_xor_b32 v33, s3, v33
    v_lshl_add_u32 v42, v33, 5, v42
    v_add_u32 v42, 17408, v42
    s_lshl_b32 s7, s33, 2
    s_add_u32 s7, s7, s3
    s_mul_i32 s87, s7, 5120
    s_add_u32 s87, s87, 393216
    s_add_u32 s86, s87, 2560
    v_and_b32 v13, 7, v1
    v_mul_u32_u24 v13, 640, v13
    v_lshrrev_b32 v54, 4, v10
    v_add_u32 v54, s64, v54
    v_lshlrev_b32 v54, 4, v54
    v_sub_u32 v54, 0, v54
    v_lshrrev_b32 v15, 3, v2
    v_lshlrev_b32 v15, 4, v15
    v_and_b32 v34, 4, v2
    v_add_u32 v15, v15, v34
    v_lshl_add_u32 v15, v3, 5, v15
    s_lshl_b32 s7, s3, 7
    v_add_u32 v15, s7, v15
    v_bfe_u32 v34, v2, 1, 1
    v_lshl_add_u32 v15, v34, 9, v15
    v_and_b32 v34, 1, v2
    v_lshl_add_u32 v15, v34, 1, v15
    v_and_b32 v14, 1, v2
    v_mul_u32_u24 v12, 512, v14
    v_lshl_add_u32 v12, v3, 4, v12
    v_bfe_u32 v33, v2, 1, 1
    v_lshl_add_u32 v12, v33, 6, v12
    v_mul_u32_u24 v14, 0xaaaa, v14
    v_add_u32 v14, 0x4444, v14
    v_lshl_or_b32 v14, v14, 16, v14
    s_lshl_b32 s7, s32, 8
    s_lshl_b32 s26, s3, 6
    s_add_u32 s7, s7, s26
    v_lshlrev_b32 v58, 2, v2
    v_add_u32 v58, s7, v58
    v_lshrrev_b32 v52, 4, v58
    v_add_u32 v52, s64, v52
    s_mul_i32 s26, s33, 2560
    s_add_u32 s26, s26, 327680
    v_mov_b32 v56, 0
    v_mov_b32 v57, 1
    v_mov_b32 v59, s3
    v_mov_b32 v128, 0
    v_mov_b32 v129, 0
    v_mov_b32 v130, 0
    v_mov_b32 v131, 0
    v_mov_b32 v132, 0
    v_mov_b32 v133, 0
    v_mov_b32 v134, 0
    v_mov_b32 v135, 0
    s_mov_b32 s35, 880281
    v_mov_b32 v32, 8
Lw_16:
    s_sub_u32 s35, s35, 1
    s_cbranch_scc1 Lx_17
    ds_read_b32 v33, v32
    s_waitcnt lgkmcnt(0)
    v_readfirstlane_b32 s34, v33
    s_nop 0
    s_cmp_ge_u32 s34, 2
    s_cbranch_scc1 Lx_17
    s_sleep 8
    s_branch Lw_16
Lx_17:
    ds_read_b64_tr_b16 v[64:65], v42 offset:0
    ds_read_b64_tr_b16 v[66:67], v42 offset:512
    ds_read_b64_tr_b16 v[68:69], v42 offset:4096
    ds_read_b64_tr_b16 v[70:71], v42 offset:4608
    ds_read_b64_tr_b16 v[72:73], v42 offset:8192
    ds_read_b64_tr_b16 v[74:75], v42 offset:8704
    ds_read_b64_tr_b16 v[76:77], v42 offset:12288
    ds_read_b64_tr_b16 v[78:79], v42 offset:12800
    s_waitcnt lgkmcnt(6)
    ds_read_b64_tr_b16 v[80:81], v42 offset:16384
    ds_read_b64_tr_b16 v[82:83], v42 offset:16896
    ds_read_b64_tr_b16 v[84:85], v42 offset:20480
    ds_read_b64_tr_b16 v[86:87], v42 offset:20992
    ds_read_b64_tr_b16 v[88:89], v42 offset:24576
    ds_read_b64_tr_b16 v[90:91], v42 offset:25088
    ds_read_b64_tr_b16 v[92:93], v42 offset:28672
    ds_read_b64_tr_b16 v[94:95], v42 offset:29184
    s_waitcnt lgkmcnt(6)
    ds_read_b64_tr_b16 v[96:97], v42 offset:32768
    ds_read_b64_tr_b16 v[98:99], v42 offset:33280
    ds_read_b64_tr_b16 v[100:101], v42 offset:36864
    ds_read_b64_tr_b16 v[102:103], v42 offset:37376
    ds_read_b64_tr_b16 v[104:105], v42 offset:40960
    ds_read_b64_tr_b16 v[106:107], v42 offset:41472
    ds_read_b64_tr_b16 v[108:109], v42 offset:45056
    ds_read_b64_tr_b16 v[110:111], v42 offset:45568
    s_waitcnt lgkmcnt(6)
    ds_read_b64_tr_b16 v[112:113], v42 offset:49152
    ds_read_b64_tr_b16 v[114:115], v42 offset:49664
    ds_read_b64_tr_b16 v[116:117], v42 offset:53248
    ds_read_b64_tr_b16 v[118:119], v42 offset:53760
    ds_read_b64_tr_b16 v[120:121], v42 offset:57344
    ds_read_b64_tr_b16 v[122:123], v42 offset:57856
    ds_read_b64_tr_b16 v[124:125], v42 offset:61440
    ds_read_b64_tr_b16 v[126:127], v42 offset:61952
    s_waitcnt lgkmcnt(6)
    s_mov_b32 s94, 0x01010101
    s_mov_b32 s93, 0
    v_mov_b32 v59, 36
    s_mov_b64 s[28:29], s[86:87]
    s_mov_b32 s27, s26
    s_mov_b32 s86, 268435456
    s_mov_b32 s87, 268435456
    s_mov_b32 s26, 268435456
    s_branch L_wgo
L_wreal:
    s_mov_b64 exec, -1
    v_mov_b32 v59, s3
    s_mov_b64 s[86:87], s[28:29]
    s_mov_b32 s26, s27
    v_mov_b32 v128, 0
    v_mov_b32 v129, 0
    v_mov_b32 v130, 0
    v_mov_b32 v131, 0
    v_mov_b32 v132, 0
    v_mov_b32 v133, 0
    v_mov_b32 v134, 0
    v_mov_b32 v135, 0
    s_cmp_eq_u32 s3, 0
    s_cbranch_scc0 Lnf_18
    s_mov_b32 s95, 6
    s_call_b64 s[30:31], L_fetch
Lnf_18:
    s_mov_b32 s35, 2155172
    v_mov_b32 v32, 4
Lw_19:
    s_sub_u32 s35, s35, 1
    s_cbranch_scc1 Lx_20
    ds_read_b32 v33, v32
    s_waitcnt lgkmcnt(0)
    v_readfirstlane_b32 s34, v33
    s_nop 0
    s_cmp_ge_u32 s34, 5
    s_cbranch_scc1 Lx_20
    s_sleep 2
    s_branch Lw_19
Lx_20:
    s_mov_b32 s93, 2000000
L_wgo:
    s_mov_b32 s35, s93
L_wp:
    buffer_load_dwordx4 v[44:47], v13, s[16:19], s87 offen offset:512 sc1
    buffer_load_dwordx2 v[18:19], v10, s[16:19], s87 offen offset:0 sc1
    buffer_load_dwordx2 v[20:21], v10, s[16:19], s87 offen offset:640 sc1
    buffer_load_dwordx2 v[22:23], v10, s[16:19], s87 offen offset:1280 sc1
    buffer_load_dwordx2 v[24:25], v10, s[16:19], s87 offen offset:1920 sc1
    buffer_load_dwordx2 v[26:27], v10, s[16:19], s86 offen offset:0 sc1
    buffer_load_dwordx2 v[28:29], v10, s[16:19], s86 offen offset:640 sc1
    buffer_load_dwordx2 v[30:31], v10, s[16:19], s86 offen offset:1280 sc1
    buffer_load_dwordx2 v[32:33], v10, s[16:19], s86 offen offset:1920 sc1
    s_waitcnt vmcnt(8)
    v_max_f32_dpp v34, v44, v44 row_ror:1 row_mask:0xf bank_mask:0xf
    v_xor_b32 v37, s64, v45
    v_bitop3_b32 v37, v47, s64, v37 bitop3:0xbe
    v_max_f32_dpp v34, v34, v34 row_ror:2 row_mask:0xf bank_mask:0xf
    v_cmp_ne_u32 vcc, 0, v37
    s_sub_u32 s35, s35, 1
    s_cbranch_scc1 L_wc
    s_cbranch_vccnz L_wp
L_wc:
    v_max_f32_dpp v34, v34, v34 row_ror:4 row_mask:0xf bank_mask:0xf
    v_sub_f32 v34, v44, v34
    v_exp_f32 v34, v34
    s_waitcnt vmcnt(6)
    v_add3_u32 v36, v54, v18, v19
    v_mul_f32 v35, v34, v46
    v_add3_u32 v36, v36, v20, v21
    v_mul_f32_dpp v38, v34, v18 row_newbcast:0 row_mask:0xf bank_mask:0xf
    v_mul_f32_dpp v39, v34, v19 row_newbcast:0 row_mask:0xf bank_mask:0xf
    v_add_f32_dpp v35, v35, v35 row_ror:1 row_mask:0xf bank_mask:0xf
    v_fmac_f32_dpp v38, v34, v20 row_newbcast:1 row_mask:0xf bank_mask:0xf
    v_fmac_f32_dpp v39, v34, v21 row_newbcast:1 row_mask:0xf bank_mask:0xf
    v_add_f32_dpp v35, v35, v35 row_ror:2 row_mask:0xf bank_mask:0xf
    s_waitcnt vmcnt(5)
    v_add3_u32 v36, v36, v22, v23
    v_fmac_f32_dpp v38, v34, v22 row_newbcast:2 row_mask:0xf bank_mask:0xf
    v_fmac_f32_dpp v39, v34, v23 row_newbcast:2 row_mask:0xf bank_mask:0xf
    v_add_f32_dpp v35, v35, v35 row_ror:4 row_mask:0xf bank_mask:0xf
    s_waitcnt vmcnt(4)
    v_add3_u32 v36, v36, v24, v25
    v_fmac_f32_dpp v38, v34, v24 row_newbcast:3 row_mask:0xf bank_mask:0xf
    v_fmac_f32_dpp v39, v34, v25 row_newbcast:3 row_mask:0xf bank_mask:0xf
    v_rcp_f32 v35, v35
    s_waitcnt vmcnt(3)
    v_add3_u32 v36, v36, v26, v27
    v_fmac_f32_dpp v38, v34, v26 row_newbcast:4 row_mask:0xf bank_mask:0xf
    v_fmac_f32_dpp v39, v34, v27 row_newbcast:4 row_mask:0xf bank_mask:0xf
    s_waitcnt vmcnt(2)
    v_add3_u32 v36, v36, v28, v29
    v_fmac_f32_dpp v38, v34, v28 row_newbcast:5 row_mask:0xf bank_mask:0xf
    v_fmac_f32_dpp v39, v34, v29 row_newbcast:5 row_mask:0xf bank_mask:0xf
    s_waitcnt vmcnt(1)
    v_add3_u32 v36, v36, v30, v31
    v_fmac_f32_dpp v38, v34, v30 row_newbcast:6 row_mask:0xf bank_mask:0xf
    v_fmac_f32_dpp v39, v34, v31 row_newbcast:6 row_mask:0xf bank_mask:0xf
    s_waitcnt vmcnt(0)
    v_add3_u32 v36, v36, v32, v33
    v_fmac_f32_dpp v38, v34, v32 row_newbcast:7 row_mask:0xf bank_mask:0xf
    v_fmac_f32_dpp v39, v34, v33 row_newbcast:7 row_mask:0xf bank_mask:0xf
    v_and_or_b32 v36, v36, s69, v37
    v_cmp_ne_u32 vcc, 0, v36
    v_mul_f32 v38, v38, v35
    v_mul_f32 v39, v39, v35
    s_cbranch_scc1 L_wpx
    s_cbranch_vccnz L_wp
L_wpx:
    v_cvt_pk_bf16_f32 v38, v38, v39
    ds_write_b16 v15, v38 offset:4864
    ds_write_b16_d16_hi v15, v38 offset:4872
    ds_write_b8 v59, v57 offset:24
    s_mov_b32 s35, s93
L_wx:
    ds_read_b32 v36, v56 offset:24
    ds_read_b128 v[16:19], v12 offset:4864
    ds_read_b128 v[20:23], v12 offset:4992
    ds_read_b128 v[24:27], v12 offset:5120
    ds_read_b128 v[28:31], v12 offset:5248
    s_waitcnt lgkmcnt(0)
    v_cmp_ne_u32 vcc, s94, v36
    s_cbranch_vccz L_wxx
    s_sub_u32 s35, s35, 1
    s_cbranch_scc1 L_wxx
    s_branch L_wx
L_wxx:
    v_smfmac_f32_16x16x64_bf16 v[128:131], v[16:19], v[64:71], v14
    v_smfmac_f32_16x16x64_bf16 v[132:135], v[16:19], v[72:79], v14
    v_smfmac_f32_16x16x64_bf16 v[128:131], v[20:23], v[80:87], v14
    v_smfmac_f32_16x16x64_bf16 v[132:135], v[20:23], v[88:95], v14
    v_smfmac_f32_16x16x64_bf16 v[128:131], v[24:27], v[96:103], v14
    v_smfmac_f32_16x16x64_bf16 v[132:135], v[24:27], v[104:111], v14
    v_smfmac_f32_16x16x64_bf16 v[128:131], v[28:31], v[112:119], v14
    v_smfmac_f32_16x16x64_bf16 v[132:135], v[28:31], v[120:127], v14
    s_mov_b64 exec, 0xffff
    s_nop 5
    v_add_f32 v32, v128, v129
    v_add_f32 v33, v134, v135
    v_add_f32 v32, v32, v33
    v_bfi_b32 v32, s69, v52, v32
    buffer_store_dword v32, v58, s[16:19], s26 offen sc1
    s_cmp_eq_u32 s93, 0
    s_cbranch_scc1 L_wreal
    s_endpgm
L_ffn:
    s_sub_u32 s66, s4, 5
    s_getreg_b32 s68, hwreg(HW_REG_XCC_ID)
    s_cmp_eq_u32 s3, 1
    s_cbranch_scc0 L_nx
    s_lshl_b32 s6, s66, 6
    s_add_u32 s6, s6, 319488
    v_mov_b32 v32, s68
    v_mov_b32 v33, s64
    v_mov_b32 v34, 0
    s_mov_b64 exec, 1
    buffer_store_dwordx2 v[32:33], v34, s[16:19], s6 offen sc1
    s_mov_b64 exec, -1
L_nx:
    v_lshrrev_b32 v32, 3, v1
    v_mul_u32_u24 v32, 3456, v32
    v_and_b32 v33, 7, v1
    v_lshlrev_b32 v33, 4, v33
    v_add_u32 v45, v32, v33
    v_lshl_add_u32 v46, v3, 3, v5
    v_lshlrev_b32 v46, 7, v46
    v_lshl_add_u32 v46, v4, 3, v46
    s_lshl_b32 s6, s3, 5
    s_add_u32 s6, s6, 17408
    v_add_u32 v46, s6, v46
    v_add_u32 v47, 40960, v46
    v_add_u32 v48, 40960, v47
    s_mov_b32 s8, s48
    s_mov_b32 s9, s49
    s_mov_b32 s10, 2211840
    s_mov_b32 s11, 0x20000
    s_mov_b32 s12, s50
    s_mov_b32 s13, s51
    s_mov_b32 s14, 2211840
    s_mov_b32 s15, 0x20000
    s_cmp_ge_u32 s3, 2
    s_cbranch_scc0 Lld_21
    s_mov_b32 s35, 880281
    v_mov_b32 v32, 52
Lw_22:
    s_sub_u32 s35, s35, 1
    s_cbranch_scc1 Lx_23
    ds_read_b32 v33, v32
    s_waitcnt lgkmcnt(0)
    v_readfirstlane_b32 s34, v33
    s_nop 0
    s_cmp_ge_u32 s34, 1
    s_cbranch_scc1 Lx_23
    s_sleep 8
    s_branch Lw_22
Lx_23:
    s_lshl_b32 s24, s66, 7
    s_sub_u32 s7, s3, 2
    s_mul_i32 s6, s7, 552960
    s_add_u32 s24, s24, s6
    s_add_u32 s24, s24, 0
    s_mul_i32 s25, s7, 20480
    s_add_u32 s25, s25, 17408
    s_mov_b32 s28, 20
L_dg0:
    s_mov_b32 m0, s25
    s_add_u32 s25, s25, 1024
    buffer_load_dwordx4 v45, s[8:11], s24 offen nt lds
    s_add_u32 s24, s24, 27648
    s_sub_u32 s28, s28, 1
    s_cmp_lg_u32 s28, 0
    s_cbranch_scc1 L_dg0
    s_lshl_b32 s24, s66, 7
    s_sub_u32 s7, s3, 2
    s_mul_i32 s6, s7, 552960
    s_add_u32 s24, s24, s6
    s_add_u32 s24, s24, 1105920
    s_mul_i32 s25, s7, 20480
    s_add_u32 s25, s25, 58368
    s_mov_b32 s28, 20
L_dg1:
    s_mov_b32 m0, s25
    s_add_u32 s25, s25, 1024
    buffer_load_dwordx4 v45, s[8:11], s24 offen nt lds
    s_add_u32 s24, s24, 27648
    s_sub_u32 s28, s28, 1
    s_cmp_lg_u32 s28, 0
    s_cbranch_scc1 L_dg1
    s_lshl_b32 s24, s66, 7
    s_sub_u32 s7, s3, 2
    s_mul_i32 s6, s7, 552960
    s_add_u32 s24, s24, s6
    s_add_u32 s24, s24, 0
    s_mul_i32 s25, s7, 20480
    s_add_u32 s25, s25, 99328
    s_mov_b32 s28, 20
L_dg2:
    s_mov_b32 m0, s25
    s_add_u32 s25, s25, 1024
    buffer_load_dwordx4 v45, s[12:15], s24 offen nt lds
    s_add_u32 s24, s24, 27648
    s_sub_u32 s28, s28, 1
    s_cmp_lg_u32 s28, 0
    s_cbranch_scc1 L_dg2
    s_waitcnt vmcnt(40)
    s_mov_b64 exec, 1
    v_mov_b32 v32, 8
    v_mov_b32 v33, 1
    ds_add_u32 v32, v33
    s_mov_b64 exec, -1
Lld_21:
    s_mov_b32 s35, 1453488
    v_mov_b32 v32, 8
Lw_24:
    s_sub_u32 s35, s35, 1
    s_cbranch_scc1 Lx_25
    ds_read_b32 v33, v32
    s_waitcnt lgkmcnt(0)
    v_readfirstlane_b32 s34, v33
    s_nop 0
    s_cmp_ge_u32 s34, 2
    s_cbranch_scc1 Lx_25
    s_sleep 4
    s_branch Lw_24
Lx_25:
    ds_read_b64_tr_b16 v[64:65], v46 offset:0
    ds_read_b64_tr_b16 v[66:67], v46 offset:512
    ds_read_b64_tr_b16 v[68:69], v46 offset:4096
    ds_read_b64_tr_b16 v[70:71], v46 offset:4608
    ds_read_b64_tr_b16 v[72:73], v46 offset:8192
    ds_read_b64_tr_b16 v[74:75], v46 offset:8704
    ds_read_b64_tr_b16 v[76:77], v46 offset:12288
    ds_read_b64_tr_b16 v[78:79], v46 offset:12800
    ds_read_b64_tr_b16 v[80:81], v46 offset:16384
    ds_read_b64_tr_b16 v[82:83], v46 offset:16896
    s_waitcnt lgkmcnt(0)
    ds_read_b64_tr_b16 v[84:85], v46 offset:20480
    ds_read_b64_tr_b16 v[86:87], v46 offset:20992
    ds_read_b64_tr_b16 v[88:89], v46 offset:24576
    ds_read_b64_tr_b16 v[90:91], v46 offset:25088
    ds_read_b64_tr_b16 v[92:93], v46 offset:28672
    ds_read_b64_tr_b16 v[94:95], v46 offset:29184
    ds_read_b64_tr_b16 v[96:97], v46 offset:32768
    ds_read_b64_tr_b16 v[98:99], v46 offset:33280
    ds_read_b64_tr_b16 v[100:101], v46 offset:36864
    ds_read_b64_tr_b16 v[102:103], v46 offset:37376
    s_waitcnt lgkmcnt(0)
    s_mov_b64 exec, 1
    v_mov_b32 v32, 40
    v_mov_b32 v33, 1
    ds_add_u32 v32, v33
    s_mov_b64 exec, -1
    s_cmp_ge_u32 s3, 2
    s_cbranch_scc0 Lld_26
    s_mov_b32 s35, 2155172
    v_mov_b32 v32, 40
Lw_27:
    s_sub_u32 s35, s35, 1
    s_cbranch_scc1 Lx_28
    ds_read_b32 v33, v32
    s_waitcnt lgkmcnt(0)
    v_readfirstlane_b32 s34, v33
    s_nop 0
    s_cmp_ge_u32 s34, 4
    s_cbranch_scc1 Lx_28
    s_sleep 2
    s_branch Lw_27
Lx_28:
    s_lshl_b32 s24, s66, 7
    s_sub_u32 s7, s3, 2
    s_mul_i32 s6, s7, 552960
    s_add_u32 s24, s24, s6
    s_add_u32 s24, s24, 1105920
    s_mul_i32 s25, s7, 20480
    s_add_u32 s25, s25, 17408
    s_mov_b32 s28, 20
L_dg3:
    s_mov_b32 m0, s25
    s_add_u32 s25, s25, 1024
    buffer_load_dwordx4 v45, s[12:15], s24 offen nt lds
    s_add_u32 s24, s24, 27648
    s_sub_u32 s28, s28, 1
    s_cmp_lg_u32 s28, 0
    s_cbranch_scc1 L_dg3
    s_waitcnt vmcnt(20)
    s_mov_b64 exec, 1
    v_mov_b32 v32, 8
    v_mov_b32 v33, 1
    ds_add_u32 v32, v33
    s_mov_b64 exec, -1
Lld_26:
    s_mov_b32 s35, 1453488
    v_mov_b32 v32, 8
Lw_29:
    s_sub_u32 s35, s35, 1
    s_cbranch_scc1 Lx_30
    ds_read_b32 v33, v32
    s_waitcnt lgkmcnt(0)
    v_readfirstlane_b32 s34, v33
    s_nop 0
    s_cmp_ge_u32 s34, 4
    s_cbranch_scc1 Lx_30
    s_sleep 4
    s_branch Lw_29
Lx_30:
    ds_read_b64_tr_b16 v[104:105], v47 offset:0
    ds_read_b64_tr_b16 v[106:107], v47 offset:512
    ds_read_b64_tr_b16 v[108:109], v47 offset:4096
    ds_read_b64_tr_b16 v[110:111], v47 offset:4608
    ds_read_b64_tr_b16 v[112:113], v47 offset:8192
    ds_read_b64_tr_b16 v[114:115], v47 offset:8704
    ds_read_b64_tr_b16 v[116:117], v47 offset:12288
    ds_read_b64_tr_b16 v[118:119], v47 offset:12800
    ds_read_b64_tr_b16 v[120:121], v47 offset:16384
    ds_read_b64_tr_b16 v[122:123], v47 offset:16896
    s_waitcnt lgkmcnt(0)
    ds_read_b64_tr_b16 v[124:125], v47 offset:20480
    ds_read_b64_tr_b16 v[126:127], v47 offset:20992
    ds_read_b64_tr_b16 v[128:129], v47 offset:24576
    ds_read_b64_tr_b16 v[130:131], v47 offset:25088
    ds_read_b64_tr_b16 v[132:133], v47 offset:28672
    ds_read_b64_tr_b16 v[134:135], v47 offset:29184
    ds_read_b64_tr_b16 v[136:137], v47 offset:32768
    ds_read_b64_tr_b16 v[138:139], v47 offset:33280
    ds_read_b64_tr_b16 v[140:141], v47 offset:36864
    ds_read_b64_tr_b16 v[142:143], v47 offset:37376
    s_waitcnt lgkmcnt(0)
    ds_read_b64_tr_b16 v[144:145], v48 offset:0
    ds_read_b64_tr_b16 v[146:147], v48 offset:512
    ds_read_b64_tr_b16 v[148:149], v48 offset:4096
    ds_read_b64_tr_b16 v[150:151], v48 offset:4608
    ds_read_b64_tr_b16 v[152:153], v48 offset:8192
    ds_read_b64_tr_b16 v[154:155], v48 offset:8704
    ds_read_b64_tr_b16 v[156:157], v48 offset:12288
    ds_read_b64_tr_b16 v[158:159], v48 offset:12800
    ds_read_b64_tr_b16 v[160:161], v48 offset:16384
    ds_read_b64_tr_b16 v[162:163], v48 offset:16896
    s_waitcnt lgkmcnt(0)
    ds_read_b64_tr_b16 v[164:165], v48 offset:20480
    ds_read_b64_tr_b16 v[166:167], v48 offset:20992
    ds_read_b64_tr_b16 v[168:169], v48 offset:24576
    ds_read_b64_tr_b16 v[170:171], v48 offset:25088
    ds_read_b64_tr_b16 v[172:173], v48 offset:28672
    ds_read_b64_tr_b16 v[174:175], v48 offset:29184
    ds_read_b64_tr_b16 v[176:177], v48 offset:32768
    ds_read_b64_tr_b16 v[178:179], v48 offset:33280
    ds_read_b64_tr_b16 v[180:181], v48 offset:36864
    ds_read_b64_tr_b16 v[182:183], v48 offset:37376
    s_waitcnt lgkmcnt(0)
    s_mov_b64 exec, 1
    v_mov_b32 v32, 40
    v_mov_b32 v33, 1
    ds_add_u32 v32, v33
    s_mov_b64 exec, -1
    s_cmp_ge_u32 s3, 2
    s_cbranch_scc0 Lld_31
    s_mov_b32 s35, 2155172
    v_mov_b32 v32, 40
Lw_32:
    s_sub_u32 s35, s35, 1
    s_cbranch_scc1 Lx_33
    ds_read_b32 v33, v32
    s_waitcnt lgkmcnt(0)
    v_readfirstlane_b32 s34, v33
    s_nop 0
    s_cmp_ge_u32 s34, 8
    s_cbranch_scc1 Lx_33
    s_sleep 2
    s_branch Lw_32
Lx_33:
    s_mov_b32 s8, s52
    s_mov_b32 s9, s53
    s_mov_b32 s10, 2211840
    s_mov_b32 s11, 0x20000
    v_add_u32 v32, 0, v1
    v_mul_u32_u24 v33, 3277, v32
    v_lshrrev_b32 v33, 16, v33
    v_mul_u32_u24 v34, 20, v33
    v_sub_u32 v32, v32, v34
    v_mul_u32_u24 v33, 1280, v33
    v_lshl_add_u32 v40, v32, 4, v33
    v_add_u32 v32, 64, v1
    v_mul_u32_u24 v33, 3277, v32
    v_lshrrev_b32 v33, 16, v33
    v_mul_u32_u24 v34, 20, v33
    v_sub_u32 v32, v32, v34
    v_mul_u32_u24 v33, 1280, v33
    v_lshl_add_u32 v41, v32, 4, v33
    v_add_u32 v32, 128, v1
    v_mul_u32_u24 v33, 3277, v32
    v_lshrrev_b32 v33, 16, v33
    v_mul_u32_u24 v34, 20, v33
    v_sub_u32 v32, v32, v34
    v_mul_u32_u24 v33, 1280, v33
    v_lshl_add_u32 v42, v32, 4, v33
    v_add_u32 v32, 192, v1
    v_mul_u32_u24 v33, 3277, v32
    v_lshrrev_b32 v33, 16, v33
    v_mul_u32_u24 v34, 20, v33
    v_sub_u32 v32, v32, v34
    v_mul_u32_u24 v33, 1280, v33
    v_lshl_add_u32 v43, v32, 4, v33
    v_add_u32 v32, 256, v1
    v_mul_u32_u24 v33, 3277, v32
    v_lshrrev_b32 v33, 16, v33
    v_mul_u32_u24 v34, 20, v33
    v_sub_u32 v32, v32, v34
    v_mul_u32_u24 v33, 1280, v33
    v_lshl_add_u32 v44, v32, 4, v33
    s_mul_i32 s24, s66, 81920
    s_sub_u32 s7, s3, 2
    s_mul_i32 s6, s7, 640
    s_add_u32 s24, s24, s6
    s_mul_i32 s25, s7, 40960
    s_add_u32 s25, s25, 58368
    s_mov_b32 s28, 4
L_dd:
    s_mov_b32 m0, s25
    s_add_u32 s26, s24, 320
    buffer_load_dwordx4 v40, s[8:11], s24 offen nt lds
    s_add_u32 s27, s25, 20480
    s_mov_b32 m0, s27
    s_add_u32 s25, s25, 1024
    buffer_load_dwordx4 v40, s[8:11], s26 offen nt lds
    s_mov_b32 m0, s25
    s_add_u32 s26, s24, 320
    buffer_load_dwordx4 v41, s[8:11], s24 offen nt lds
    s_add_u32 s27, s25, 20480
    s_mov_b32 m0, s27
    s_add_u32 s25, s25, 1024
    buffer_load_dwordx4 v41, s[8:11], s26 offen nt lds
    s_mov_b32 m0, s25
    s_add_u32 s26, s24, 320
    buffer_load_dwordx4 v42, s[8:11], s24 offen nt lds
    s_add_u32 s27, s25, 20480
    s_mov_b32 m0, s27
    s_add_u32 s25, s25, 1024
    buffer_load_dwordx4 v42, s[8:11], s26 offen nt lds
    s_mov_b32 m0, s25
    s_add_u32 s26, s24, 320
    buffer_load_dwordx4 v43, s[8:11], s24 offen nt lds
    s_add_u32 s27, s25, 20480
    s_mov_b32 m0, s27
    s_add_u32 s25, s25, 1024
    buffer_load_dwordx4 v43, s[8:11], s26 offen nt lds
    s_mov_b32 m0, s25
    s_add_u32 s26, s24, 320
    buffer_load_dwordx4 v44, s[8:11], s24 offen nt lds
    s_add_u32 s27, s25, 20480
    s_mov_b32 m0, s27
    s_add_u32 s25, s25, 1024
    buffer_load_dwordx4 v44, s[8:11], s26 offen nt lds
    s_add_u32 s24, s24, 20480
    s_sub_u32 s28, s28, 1
    s_cmp_lg_u32 s28, 0
    s_cbranch_scc1 L_dd
    s_mov_b64 exec, 1
    v_mov_b32 v32, 44
    v_mov_b32 v33, 1
    ds_add_u32 v32, v33
    s_mov_b64 exec, -1
    s_waitcnt vmcnt(40)
    s_mov_b64 exec, 1
    v_mov_b32 v32, 8
    v_mov_b32 v33, 1
    ds_add_u32 v32, v33
    s_mov_b64 exec, -1
Lld_31:
    s_mov_b32 s35, 1453488
    v_mov_b32 v32, 8
Lw_34:
    s_sub_u32 s35, s35, 1
    s_cbranch_scc1 Lx_35
    ds_read_b32 v33, v32
    s_waitcnt lgkmcnt(0)
    v_readfirstlane_b32 s34, v33
    s_nop 0
    s_cmp_ge_u32 s34, 6
    s_cbranch_scc1 Lx_35
    s_sleep 4
    s_branch Lw_34
Lx_35:
    ds_read_b64_tr_b16 v[184:185], v46 offset:0
    ds_read_b64_tr_b16 v[186:187], v46 offset:512
    ds_read_b64_tr_b16 v[188:189], v46 offset:4096
    ds_read_b64_tr_b16 v[190:191], v46 offset:4608
    ds_read_b64_tr_b16 v[192:193], v46 offset:8192
    ds_read_b64_tr_b16 v[194:195], v46 offset:8704
    ds_read_b64_tr_b16 v[196:197], v46 offset:12288
    ds_read_b64_tr_b16 v[198:199], v46 offset:12800
    ds_read_b64_tr_b16 v[200:201], v46 offset:16384
    ds_read_b64_tr_b16 v[202:203], v46 offset:16896
    s_waitcnt lgkmcnt(0)
    ds_read_b64_tr_b16 v[204:205], v46 offset:20480
    ds_read_b64_tr_b16 v[206:207], v46 offset:20992
    ds_read_b64_tr_b16 v[208:209], v46 offset:24576
    ds_read_b64_tr_b16 v[210:211], v46 offset:25088
    ds_read_b64_tr_b16 v[212:213], v46 offset:28672
    ds_read_b64_tr_b16 v[214:215], v46 offset:29184
    ds_read_b64_tr_b16 v[216:217], v46 offset:32768
    ds_read_b64_tr_b16 v[218:219], v46 offset:33280
    ds_read_b64_tr_b16 v[220:221], v46 offset:36864
    ds_read_b64_tr_b16 v[222:223], v46 offset:37376
    s_waitcnt lgkmcnt(0)
    s_waitcnt vmcnt(0)
    s_mov_b64 exec, 1
    v_mov_b32 v32, 40
    v_mov_b32 v33, 1
    ds_add_u32 v32, v33
    s_mov_b64 exec, -1
    s_mov_b32 s35, 134989
    v_mov_b32 v32, 20
Lw_36:
    s_sub_u32 s35, s35, 1
    s_cbranch_scc1 Lx_37
    ds_read_b32 v33, v32
    s_waitcnt lgkmcnt(0)
    v_readfirstlane_b32 s34, v33
    s_nop 0
    s_cmp_ge_u32 s34, 48
    s_cbranch_scc1 Lx_37
    s_sleep 64
    s_branch Lw_36
Lx_37:
    s_mov_b32 s35, 1453488
    v_mov_b32 v32, 40
Lw_38:
    s_sub_u32 s35, s35, 1
    s_cbranch_scc1 Lx_39
    ds_read_b32 v33, v32
    s_waitcnt lgkmcnt(0)
    v_readfirstlane_b32 s34, v33
    s_nop 0
    s_cmp_ge_u32 s34, 12
    s_cbranch_scc1 Lx_39
    s_sleep 4
    s_branch Lw_38
Lx_39:
    s_mul_i32 s6, s3, 160
    v_lshlrev_b32 v34, 2, v1
    v_add_u32 v34, s6, v34
    v_cmp_gt_u32 s[86:87], 40, v1
    s_mov_b32 s12, s36
    s_mov_b32 s13, s37
    s_mov_b32 s14, 1280
    s_mov_b32 s15, 0x20000
    v_mov_b32 v35, 268435456
    v_lshlrev_b32 v36, 1, v34
    v_cndmask_b32 v36, v35, v36, s[86:87]
    buffer_load_dwordx2 v[38:39], v36, s[12:15], 0 offen
    v_lshlrev_b32 v13, 2, v34
    v_lshrrev_b32 v9, 4, v13
    v_add_u32 v9, s64, v9
    v_lshlrev_b32 v9, 5, v9
    v_sub_u32 v9, 0, v9
    v_cndmask_b32 v9, 0, v9, s[86:87]
    v_cndmask_b32 v13, v35, v13, s[86:87]
    v_mov_b32 v37, 0xd00
    v_cndmask_b32 v15, v37, v34, s[86:87]
    v_mov_b32 v37, 0x500
    v_lshlrev_b32 v8, 1, v34
    v_cndmask_b32 v8, v37, v8, s[86:87]
    v_cndmask_b32 v34, 0, v34, s[86:87]
    v_lshrrev_b32 v40, 7, v34
    v_lshlrev_b32 v40, 10, v40
    v_and_b32 v37, 63, v34
    v_lshl_add_u32 v40, v37, 4, v40
    v_bfe_u32 v37, v34, 6, 1
    v_lshl_add_u32 v40, v37, 3, v40
    v_min_u32 v62, 26, v1
    v_lshlrev_b32 v62, 6, v62
    s_mov_b32 s27, 319488
    s_mov_b32 s24, 294912
    s_mov_b32 s25, 300032
    s_mov_b32 s26, 305152
    s_mov_b32 s28, 310272
    s_mov_b32 s35, 100000
L_mg:
    s_sub_u32 s35, s35, 1
    s_cbranch_scc1 L_mgx
    buffer_load_dwordx2 v[224:225], v40, s[16:19], s24 offen offset:0 sc1
    buffer_load_dwordx2 v[226:227], v40, s[16:19], s24 offen offset:16 sc1
    buffer_load_dwordx2 v[228:229], v40, s[16:19], s24 offen offset:32 sc1
    buffer_load_dwordx2 v[230:231], v40, s[16:19], s24 offen offset:48 sc1
    buffer_load_dwordx2 v[232:233], v40, s[16:19], s25 offen offset:0 sc1
    buffer_load_dwordx2 v[234:235], v40, s[16:19], s25 offen offset:16 sc1
    buffer_load_dwordx2 v[236:237], v40, s[16:19], s25 offen offset:32 sc1
    buffer_load_dwordx2 v[238:239], v40, s[16:19], s25 offen offset:48 sc1
    buffer_load_dwordx2 v[240:241], v40, s[16:19], s26 offen offset:0 sc1
    buffer_load_dwordx2 v[242:243], v40, s[16:19], s26 offen offset:16 sc1
    buffer_load_dwordx2 v[244:245], v40, s[16:19], s26 offen offset:32 sc1
    buffer_load_dwordx2 v[246:247], v40, s[16:19], s26 offen offset:48 sc1
    buffer_load_dwordx2 v[248:249], v62, s[16:19], s27 offen sc1
    buffer_load_dwordx2 v[16:17], v40, s[16:19], s28 offen offset:0 sc1
    buffer_load_dwordx2 v[18:19], v40, s[16:19], s28 offen offset:16 sc1
    buffer_load_dwordx2 v[20:21], v40, s[16:19], s28 offen offset:32 sc1
    buffer_load_dwordx2 v[22:23], v40, s[16:19], s28 offen offset:48 sc1
    v_mov_b32 v37, 0
    s_waitcnt vmcnt(0)
    v_bitop3_b32 v37, v225, s64, v37 bitop3:0xbe
    v_bitop3_b32 v37, v227, s64, v37 bitop3:0xbe
    v_bitop3_b32 v37, v229, s64, v37 bitop3:0xbe
    v_bitop3_b32 v37, v231, s64, v37 bitop3:0xbe
    v_bitop3_b32 v37, v233, s64, v37 bitop3:0xbe
    v_bitop3_b32 v37, v235, s64, v37 bitop3:0xbe
    v_bitop3_b32 v37, v237, s64, v37 bitop3:0xbe
    v_bitop3_b32 v37, v239, s64, v37 bitop3:0xbe
    v_bitop3_b32 v37, v241, s64, v37 bitop3:0xbe
    v_bitop3_b32 v37, v243, s64, v37 bitop3:0xbe
    v_bitop3_b32 v37, v245, s64, v37 bitop3:0xbe
    v_bitop3_b32 v37, v247, s64, v37 bitop3:0xbe
    v_bitop3_b32 v37, v249, s64, v37 bitop3:0xbe
    v_bitop3_b32 v37, v17, s64, v37 bitop3:0xbe
    v_bitop3_b32 v37, v19, s64, v37 bitop3:0xbe
    v_bitop3_b32 v37, v21, s64, v37 bitop3:0xbe
    v_bitop3_b32 v37, v23, s64, v37 bitop3:0xbe
    v_cmp_ne_u32 vcc, 0, v37
    s_cbranch_vccz L_mgx
    s_sleep 64
    s_branch L_mg
L_mgx:
    v_cmp_ne_u32 vcc, s68, v248
    s_nop 0
    s_cmp_eq_u64 vcc, 0
    s_cselect_b32 s29, 2, 1
    v_mov_b32 v5, 0
    v_mov_b32 v37, s29
    ds_write_b32 v5, v37 offset:36
    v_cvt_pk_bf16_f32 v16, v16, v18
    v_cvt_pk_bf16_f32 v17, v20, v22
    ds_write_b64 v8, v[16:17] offset:29696
    v_cvt_pk_bf16_f32 v45, v224, v226
    v_lshlrev_b32 v44, 16, v45
    v_and_b32 v45, 0xffff0000, v45
    v_cvt_pk_bf16_f32 v53, v240, v242
    v_lshlrev_b32 v52, 16, v53
    v_and_b32 v53, 0xffff0000, v53
    v_cvt_pk_bf16_f32 v47, v228, v230
    v_lshlrev_b32 v46, 16, v47
    v_and_b32 v47, 0xffff0000, v47
    v_cvt_pk_bf16_f32 v55, v244, v246
    v_lshlrev_b32 v54, 16, v55
    v_and_b32 v55, 0xffff0000, v55
    v_add_f32 v52, 1.0, v52
    v_add_f32 v53, 1.0, v53
    v_add_f32 v54, 1.0, v54
    v_add_f32 v55, 1.0, v55
    v_cvt_pk_bf16_f32 v53, v52, v53
    v_cvt_pk_bf16_f32 v55, v54, v55
    v_lshlrev_b32 v52, 16, v53
    v_lshlrev_b32 v54, 16, v55
    v_and_b32 v53, 0xffff0000, v53
    v_and_b32 v55, 0xffff0000, v55
    v_lshlrev_b32 v56, 16, v38
    v_and_b32 v57, 0xffff0000, v38
    v_lshlrev_b32 v58, 16, v39
    v_and_b32 v59, 0xffff0000, v39
    v_cvt_pk_bf16_f32 v38, v52, v53
    v_cvt_pk_bf16_f32 v39, v54, v55
    v_cvt_pk_bf16_f32 v40, v232, v234
    v_cvt_pk_bf16_f32 v41, v236, v238
    v_mul_f32 v48, v44, v52
    v_mul_f32 v52, v56, v52
    v_mul_f32 v49, v45, v53
    v_mul_f32 v53, v57, v53
    v_mul_f32 v50, v46, v54
    v_mul_f32 v54, v58, v54
    v_mul_f32 v51, v47, v55
    v_mul_f32 v55, v59, v55
    v_and_b32 v14, 1, v2
    v_mul_u32_u24 v12, 640, v14
    v_lshl_add_u32 v12, v3, 4, v12
    v_bfe_u32 v33, v2, 1, 1
    v_lshl_add_u32 v12, v33, 6, v12
    v_mul_u32_u24 v14, 0xaaaa, v14
    v_add_u32 v14, 0x4444, v14
    v_lshl_or_b32 v14, v14, 16, v14
    v_and_b32 v43, 12, v2
    s_lshl_b32 s6, s3, 4
    v_add_u32 v43, s6, v43
    v_bfe_u32 v33, v2, 1, 1
    v_lshl_add_u32 v43, v33, 6, v43
    v_and_b32 v33, 1, v2
    v_lshl_add_u32 v43, v33, 1, v43
    s_lshl_b32 s6, s3, 3
    v_mov_b32 v63, s6
    v_mov_b32 v33, 32
    v_cmp_eq_u32 vcc, 63, v1
    s_nop 1
    v_cndmask_b32 v63, v33, v63, vcc
    v_mov_b32 v6, 1
    s_mov_b32 s94, 0x01010101
    v_pk_mul_f32 v[240:241], 0, 0
    v_pk_mul_f32 v[242:243], 0, 0
    v_pk_mul_f32 v[244:245], 0, 0
    v_pk_mul_f32 v[246:247], 0, 0
    v_pk_mul_f32 v[248:249], 0, 0
    v_pk_mul_f32 v[250:251], 0, 0
    v_pk_mul_f32 v[252:253], 0, 0
    v_pk_mul_f32 v[254:255], 0, 0
    s_mov_b32 s93, 2000000
    s_mov_b32 s33, 0
    v_add_u32 v15, 12544, v15
    v_add_u32 v12, 12544, v12
    v_mov_b32 v4, 40
    v_add_u32 v7, s3, v4
    s_branch L_fgu
L_fnext:
    v_pk_mul_f32 v[240:241], 0, 0
    v_pk_mul_f32 v[242:243], 0, 0
    v_pk_mul_f32 v[244:245], 0, 0
    v_pk_mul_f32 v[246:247], 0, 0
    v_pk_mul_f32 v[248:249], 0, 0
    v_pk_mul_f32 v[250:251], 0, 0
    v_pk_mul_f32 v[252:253], 0, 0
    v_pk_mul_f32 v[254:255], 0, 0
    s_cmp_eq_u32 s33, 0
    s_cbranch_scc0 L_fn1
    s_mov_b32 s33, 1
    v_mov_b32 v60, v36
    v_mov_b32 v61, v37
    v_mov_b32 v38, v40
    v_mov_b32 v39, v41
    v_add_u32 v15, 4096, v15
    v_add_u32 v12, 4096, v12
    v_add_u32 v4, 16, v4
    v_add_u32 v7, 16, v7
    s_branch L_fgu
L_fn1:
    s_mov_b32 s33, 2
    v_mov_b32 v40, v36
    v_mov_b32 v41, v37
    v_subrev_u32 v15, 16640, v15
    v_subrev_u32 v12, 16640, v12
    v_mov_b32 v4, 0
    v_mov_b32 v7, s3
    s_cmp_eq_u32 s3, 0
    s_cbranch_scc0 Lnf_40
    s_mov_b32 s95, 6
    s_call_b64 s[30:31], L_fetch
Lnf_40:
    s_mov_b32 s24, 327680
    s_mov_b32 s25, 332800
    s_mov_b32 s26, 337920
    s_mov_b32 s27, 343040
    s_mov_b32 s12, s58
    s_mov_b32 s13, s59
    s_mov_b32 s14, 1280
    s_mov_b32 s15, 0x20000
    s_mul_i32 s6, s66, 2560
    s_add_u32 s6, s6, 589824
    s_mov_b32 s35, 2155172
    v_mov_b32 v32, 4
Lw_41:
    s_sub_u32 s35, s35, 1
    s_cbranch_scc1 Lx_42
    ds_read_b32 v33, v32
    s_waitcnt lgkmcnt(0)
    v_readfirstlane_b32 s34, v33
    s_nop 0
    s_cmp_ge_u32 s34, 5
    s_cbranch_scc1 Lx_42
    s_sleep 2
    s_branch Lw_41
Lx_42:
    buffer_load_dwordx4 v[16:19], v13, s[16:19], s6 offen sc1
    buffer_load_dword v20, v8, s[12:15], 0 offen
    s_mov_b32 s93, 2000000
    s_sleep 16
    s_mov_b32 s35, s93
L_fp:
    buffer_load_dwordx4 v[224:227], v13, s[16:19], s24 offen offset:0 sc1
    buffer_load_dwordx4 v[228:231], v13, s[16:19], s24 offen offset:2560 sc1
    buffer_load_dwordx4 v[232:235], v13, s[16:19], s25 offen offset:0 sc1
    buffer_load_dwordx4 v[236:239], v13, s[16:19], s25 offen offset:2560 sc1
    buffer_load_dwordx4 v[16:19], v13, s[16:19], s26 offen offset:0 sc1
    buffer_load_dwordx4 v[20:23], v13, s[16:19], s26 offen offset:2560 sc1
    buffer_load_dwordx4 v[24:27], v13, s[16:19], s27 offen offset:0 sc1
    buffer_load_dwordx4 v[28:31], v13, s[16:19], s27 offen offset:2560 sc1
    s_waitcnt vmcnt(7)
    v_add3_u32 v36, v9, v224, v225
    v_add3_u32 v36, v36, v226, v227
    s_waitcnt vmcnt(6)
    v_add3_u32 v36, v36, v228, v229
    v_add3_u32 v36, v36, v230, v231
    v_pk_add_f32 v[224:225], v[224:225], v[228:229]
    v_pk_add_f32 v[226:227], v[226:227], v[230:231]
    s_waitcnt vmcnt(5)
    v_add3_u32 v36, v36, v232, v233
    v_add3_u32 v36, v36, v234, v235
    v_pk_add_f32 v[224:225], v[224:225], v[232:233]
    v_pk_add_f32 v[226:227], v[226:227], v[234:235]
    s_waitcnt vmcnt(4)
    v_add3_u32 v36, v36, v236, v237
    v_add3_u32 v36, v36, v238, v239
    v_pk_add_f32 v[224:225], v[224:225], v[236:237]
    v_pk_add_f32 v[226:227], v[226:227], v[238:239]
    s_waitcnt vmcnt(3)
    v_add3_u32 v36, v36, v16, v17
    v_add3_u32 v36, v36, v18, v19
    v_pk_add_f32 v[224:225], v[224:225], v[16:17]
    v_pk_add_f32 v[226:227], v[226:227], v[18:19]
    s_waitcnt vmcnt(2)
    v_add3_u32 v36, v36, v20, v21
    v_add3_u32 v36, v36, v22, v23
    v_pk_add_f32 v[224:225], v[224:225], v[20:21]
    v_pk_add_f32 v[226:227], v[226:227], v[22:23]
    s_waitcnt vmcnt(1)
    v_add3_u32 v36, v36, v24, v25
    v_add3_u32 v36, v36, v26, v27
    v_pk_add_f32 v[224:225], v[224:225], v[24:25]
    v_pk_add_f32 v[226:227], v[226:227], v[26:27]
    s_waitcnt vmcnt(0)
    v_add3_u32 v36, v36, v28, v29
    v_add3_u32 v36, v36, v30, v31
    v_pk_add_f32 v[224:225], v[224:225], v[28:29]
    v_pk_add_f32 v[226:227], v[226:227], v[30:31]
    v_and_b32 v36, s69, v36
    v_cmp_ne_u32 vcc, 0, v36
    v_pk_fma_f32 v[32:33], v[224:225], v[48:49], v[52:53]
    v_pk_fma_f32 v[34:35], v[226:227], v[50:51], v[54:55]
    v_cvt_pk_bf16_f32 v38, v32, v33
    v_cvt_pk_bf16_f32 v39, v34, v35
    s_sub_u32 s35, s35, 1
    s_cbranch_scc1 L_fgu
    s_cbranch_vccnz L_fp
L_fgu:
    ds_write_b32 v15, v38 offset:4864
    ds_write_b32 v15, v39 offset:5504
    ds_write_b8 v7, v6 offset:24
    v_pk_fma_f32 v[228:229], v[224:225], v[44:45], v[56:57]
    v_pk_fma_f32 v[230:231], v[226:227], v[46:47], v[58:59]
    v_pk_mul_f32 v[234:235], v[228:229], v[228:229]
    v_pk_add_f32 v[232:233], v[228:229], v[230:231]
    v_pk_fma_f32 v[234:235], v[230:231], v[230:231], v[234:235]
    v_add_f32 v232, v232, v233
    v_add_f32 v233, v234, v235
    s_mov_b32 s35, s93
L_x2:
    ds_read_b32 v36, v4 offset:24
    ds_read_b128 v[16:19], v12 offset:4864
    ds_read_b128 v[20:23], v12 offset:4992
    ds_read_b128 v[24:27], v12 offset:5120
    ds_read_b128 v[28:31], v12 offset:5248
    ds_read_b128 v[32:35], v12 offset:5376
    s_waitcnt lgkmcnt(0)
    v_cmp_ne_u32 vcc, s94, v36
    s_cbranch_vccz L_x2x
    s_sub_u32 s35, s35, 1
    s_cbranch_scc1 L_x2x
    s_branch L_x2
L_x2x:
    v_smfmac_f32_16x16x64_bf16 v[240:243], v[16:19], v[64:71], v14
    v_add_f32_dpp v232, v232, v232 row_ror:8 row_mask:0xf bank_mask:0xf
    v_smfmac_f32_16x16x64_bf16 v[248:251], v[16:19], v[144:151], v14
    v_add_f32_dpp v233, v233, v233 row_ror:8 row_mask:0xf bank_mask:0xf
    v_smfmac_f32_16x16x64_bf16 v[244:247], v[16:19], v[72:79], v14
    v_add_f32_dpp v232, v232, v232 row_ror:4 row_mask:0xf bank_mask:0xf
    v_smfmac_f32_16x16x64_bf16 v[252:255], v[16:19], v[152:159], v14
    v_add_f32_dpp v233, v233, v233 row_ror:4 row_mask:0xf bank_mask:0xf
    v_smfmac_f32_16x16x64_bf16 v[240:243], v[20:23], v[80:87], v14
    v_add_f32_dpp v232, v232, v232 row_ror:2 row_mask:0xf bank_mask:0xf
    v_smfmac_f32_16x16x64_bf16 v[248:251], v[20:23], v[160:167], v14
    v_add_f32_dpp v233, v233, v233 row_ror:2 row_mask:0xf bank_mask:0xf
    v_smfmac_f32_16x16x64_bf16 v[244:247], v[20:23], v[88:95], v14
    v_add_f32_dpp v232, v232, v232 row_ror:1 row_mask:0xf bank_mask:0xf
    v_smfmac_f32_16x16x64_bf16 v[252:255], v[20:23], v[168:175], v14
    v_add_f32_dpp v233, v233, v233 row_ror:1 row_mask:0xf bank_mask:0xf
    v_smfmac_f32_16x16x64_bf16 v[240:243], v[24:27], v[96:103], v14
    v_add_f32_dpp v232, v232, v232 row_bcast:15 row_mask:0xa bank_mask:0xf
    v_smfmac_f32_16x16x64_bf16 v[248:251], v[24:27], v[176:183], v14
    v_add_f32_dpp v233, v233, v233 row_bcast:15 row_mask:0xa bank_mask:0xf
    v_smfmac_f32_16x16x64_bf16 v[244:247], v[24:27], v[104:111], v14
    v_add_f32_dpp v232, v232, v232 row_bcast:31 row_mask:0xc bank_mask:0xf
    v_smfmac_f32_16x16x64_bf16 v[252:255], v[24:27], v[184:191], v14
    v_add_f32_dpp v233, v233, v233 row_bcast:31 row_mask:0xc bank_mask:0xf
    v_smfmac_f32_16x16x64_bf16 v[240:243], v[28:31], v[112:119], v14
    ds_write_b64 v63, v[232:233] offset:4096
    ds_write_b8 v7, v6 offset:28
    v_smfmac_f32_16x16x64_bf16 v[248:251], v[28:31], v[192:199], v14
    v_cvt_pk_bf16_f32 v38, v228, v229
    v_smfmac_f32_16x16x64_bf16 v[244:247], v[28:31], v[120:127], v14
    v_cvt_pk_bf16_f32 v39, v230, v231
    v_smfmac_f32_16x16x64_bf16 v[252:255], v[28:31], v[200:207], v14
    ds_write_b64 v8, v[38:39] offset:6400
    v_smfmac_f32_16x16x64_bf16 v[240:243], v[32:35], v[128:135], v14
    ds_read_b32 v36, v4 offset:28
    ds_read_b128 v[224:227], v5 offset:4096
    ds_read_b128 v[228:231], v5 offset:4112
    v_smfmac_f32_16x16x64_bf16 v[248:251], v[32:35], v[208:215], v14
    v_smfmac_f32_16x16x64_bf16 v[244:247], v[32:35], v[136:143], v14
    v_smfmac_f32_16x16x64_bf16 v[252:255], v[32:35], v[216:223], v14
    s_waitcnt lgkmcnt(0)
    v_pk_add_f32 v[224:225], v[224:225], v[226:227]
    v_pk_add_f32 v[228:229], v[228:229], v[230:231]
    v_cmp_ne_u32 vcc, s94, v36
    v_pk_add_f32 v[224:225], v[224:225], v[228:229]
    v_mul_f32 v224, 0xbacccccd, v224
    v_mul_f32 v225, 0x3acccccd, v225
    v_fma_f32 v226, -v224, v224, v225
    v_max_f32 v226, 0, v226
    v_add_f32 v226, 0x3727c5ac, v226
    v_rsq_f32 v226, v226
    s_cbranch_vccnz L_sre
L_sok:
    v_add_f32 v36, v240, v241
    v_add_f32 v37, v248, v249
    v_add_f32 v34, v246, v247
    v_add_f32 v35, v254, v255
    v_pk_add_f32 v[36:37], v[36:37], v[34:35]
    v_pk_fma_f32 v[32:33], v[60:61], v[224:225], v[36:37] op_sel_hi:[1,0,1]
    s_nop 0
    v_pk_fma_f32 v[32:33], v[32:33], v[226:227], v[40:41] op_sel_hi:[1,0,1]
    s_nop 0
    v_mul_f32 v34, 0xbfb8aa3b, v32
    v_exp_f32 v34, v34
    v_mul_f32 v33, v32, v33
    v_add_f32 v34, 1.0, v34
    v_rcp_f32 v34, v34
    s_nop 0
    v_mul_f32 v34, v34, v33
    v_cvt_pk_bf16_f32 v34, v34, v34
    ds_write_b16 v43, v34 offset:4160
    ds_write_b8 v7, v6 offset:32
    s_cmp_lg_u32 s33, 2
    s_cbranch_scc1 L_fnext
    s_endpgm
L_sre:
    s_mov_b32 s35, s93
L_sr1:
    ds_read_b32 v36, v4 offset:28
    ds_read_b128 v[224:227], v5 offset:4096
    ds_read_b128 v[228:231], v5 offset:4112
    s_waitcnt lgkmcnt(0)
    v_pk_add_f32 v[224:225], v[224:225], v[226:227]
    v_pk_add_f32 v[228:229], v[228:229], v[230:231]
    v_cmp_ne_u32 vcc, s94, v36
    v_pk_add_f32 v[224:225], v[224:225], v[228:229]
    v_mul_f32 v224, 0xbacccccd, v224
    v_mul_f32 v225, 0x3acccccd, v225
    v_fma_f32 v226, -v224, v224, v225
    v_max_f32 v226, 0, v226
    v_add_f32 v226, 0x3727c5ac, v226
    v_rsq_f32 v226, v226
    s_cbranch_vccz L_sok
    s_sub_u32 s35, s35, 1
    s_cbranch_scc1 L_sok
    s_branch L_sr1
L_dwave:
    s_waitcnt vmcnt(0)
    s_sub_u32 s66, s4, 5
    v_lshrrev_b32 v1, 4, v11
    v_and_b32 v2, 15, v1
    v_lshrrev_b32 v3, 4, v1
    s_mov_b32 s35, 1453488
    v_mov_b32 v32, 40
Lw_43:
    s_sub_u32 s35, s35, 1
    s_cbranch_scc1 Lx_44
    ds_read_b32 v33, v32
    s_waitcnt lgkmcnt(0)
    v_readfirstlane_b32 s34, v33
    s_nop 0
    s_cmp_ge_u32 s34, 12
    s_cbranch_scc1 Lx_44
    s_sleep 4
    s_branch Lw_43
Lx_44:
    s_mul_i32 s33, s3, 20480
    s_add_u32 s33, s33, 58368
    v_and_b32 v4, 3, v2
    v_lshrrev_b32 v6, 2, v2
    v_lshl_add_u32 v45, v3, 3, v6
    v_mul_u32_u24 v45, 320, v45
    v_lshl_add_u32 v45, v4, 3, v45
    v_add_u32 v45, s33, v45
    s_lshl_b32 s32, s66, 2
    s_add_u32 s32, s32, s3
    s_min_u32 s33, s32, 79
    v_and_b32 v33, 1, v1
    v_lshlrev_b32 v33, 2, v33
    v_and_b32 v34, 1, v3
    v_lshlrev_b32 v34, 1, v34
    v_lshrrev_b32 v35, 1, v3
    v_add3_u32 v33, v33, v34, v35
    s_mul_i32 s6, s33, 205
    s_lshr_b32 s6, s6, 12
    s_mul_i32 s7, s6, 20
    s_sub_u32 s7, s33, s7
    s_lshl_b32 s7, s7, 3
    s_mul_i32 s6, s6, 160
    v_add_u32 v33, s7, v33
    v_and_b32 v34, 64, v33
    v_and_b32 v35, 3, v33
    v_lshl_add_u32 v34, v35, 4, v34
    v_bfe_u32 v35, v33, 2, 4
    v_add_u32 v34, v34, v35
    v_and_b32 v35, 1, v33
    v_lshlrev_b32 v35, 4, v35
    v_bfe_u32 v36, v33, 1, 4
    v_add3_u32 v35, v35, v36, 64
    v_add_u32 v35, 64, v35
    v_cmp_gt_u32 vcc, 128, v33
    s_nop 1
    v_cndmask_b32 v34, v35, v34, vcc
    v_add_u32 v6, s6, v34
    v_and_b32 v34, 1, v1
    v_lshlrev_b32 v34, 4, v34
    s_lshl_b32 s6, s33, 5
    v_add_u32 v34, s6, v34
    v_lshrrev_b32 v7, 4, v34
    v_add_u32 v7, s64, v7
    v_cmp_gt_u32 vcc, 54, v1
    s_nop 1
    v_cndmask_b32 v7, 0, v7, vcc
    v_lshrrev_b32 v0, 1, v1
    v_mul_u32_u24 v0, 2560, v0
    v_add_u32 v0, v0, v34
    v_lshlrev_b32 v6, 1, v6
    s_mul_i32 s6, s3, 640
    v_lshlrev_b32 v62, 4, v2
    v_add_u32 v62, s6, v62
    v_lshlrev_b32 v63, 3, v2
    v_add_u32 v63, s6, v63
    v_lshrrev_b32 v47, 4, v62
    v_add_u32 v47, s64, v47
    v_add_u32 v48, 16, v47
    v_lshrrev_b32 v49, 4, v63
    v_add_u32 v49, s64, v49
    v_add_u32 v49, 32, v49
    v_and_b32 v14, 1, v2
    v_lshlrev_b32 v12, 6, v14
    v_lshl_add_u32 v12, v3, 4, v12
    v_mul_u32_u24 v14, 0xaaaa, v14
    v_add_u32 v14, 0x4444, v14
    v_lshl_or_b32 v14, v14, 16, v14
    s_add_u32 s20, s62, 589824
    s_addc_u32 s21, s63, 0
    s_mov_b32 s22, 69120
    s_mov_b32 s23, 0x20000
    s_mov_b32 s12, s58
    s_mov_b32 s13, s59
    s_mov_b32 s14, 1280
    s_mov_b32 s15, 0x20000
    s_mul_i32 s28, s66, 2560
    s_mov_b32 s6, 294912
    s_mov_b32 s94, 0x01010101
    s_mov_b32 s35, 400000
    ds_read_b64_tr_b16 v[64:65], v45 offset:0
    ds_read_b64_tr_b16 v[66:67], v45 offset:1280
    ds_read_b64_tr_b16 v[68:69], v45 offset:10240
    ds_read_b64_tr_b16 v[70:71], v45 offset:11520
    ds_read_b64_tr_b16 v[72:73], v45 offset:32
    ds_read_b64_tr_b16 v[74:75], v45 offset:1312
    ds_read_b64_tr_b16 v[76:77], v45 offset:10272
    ds_read_b64_tr_b16 v[78:79], v45 offset:11552
    s_waitcnt lgkmcnt(6)
    ds_read_b64_tr_b16 v[80:81], v45 offset:64
    ds_read_b64_tr_b16 v[82:83], v45 offset:1344
    ds_read_b64_tr_b16 v[84:85], v45 offset:10304
    ds_read_b64_tr_b16 v[86:87], v45 offset:11584
    ds_read_b64_tr_b16 v[88:89], v45 offset:96
    ds_read_b64_tr_b16 v[90:91], v45 offset:1376
    ds_read_b64_tr_b16 v[92:93], v45 offset:10336
    ds_read_b64_tr_b16 v[94:95], v45 offset:11616
    s_waitcnt lgkmcnt(6)
    ds_read_b64_tr_b16 v[96:97], v45 offset:128
    ds_read_b64_tr_b16 v[98:99], v45 offset:1408
    ds_read_b64_tr_b16 v[100:101], v45 offset:10368
    ds_read_b64_tr_b16 v[102:103], v45 offset:11648
    ds_read_b64_tr_b16 v[104:105], v45 offset:160
    ds_read_b64_tr_b16 v[106:107], v45 offset:1440
    ds_read_b64_tr_b16 v[108:109], v45 offset:10400
    ds_read_b64_tr_b16 v[110:111], v45 offset:11680
    s_waitcnt lgkmcnt(6)
    ds_read_b64_tr_b16 v[112:113], v45 offset:192
    ds_read_b64_tr_b16 v[114:115], v45 offset:1472
    ds_read_b64_tr_b16 v[116:117], v45 offset:10432
    ds_read_b64_tr_b16 v[118:119], v45 offset:11712
    ds_read_b64_tr_b16 v[120:121], v45 offset:224
    ds_read_b64_tr_b16 v[122:123], v45 offset:1504
    ds_read_b64_tr_b16 v[124:125], v45 offset:10464
    ds_read_b64_tr_b16 v[126:127], v45 offset:11744
    s_waitcnt lgkmcnt(6)
    ds_read_b64_tr_b16 v[128:129], v45 offset:256
    ds_read_b64_tr_b16 v[130:131], v45 offset:1536
    ds_read_b64_tr_b16 v[132:133], v45 offset:10496
    ds_read_b64_tr_b16 v[134:135], v45 offset:11776
    ds_read_b64_tr_b16 v[136:137], v45 offset:288
    ds_read_b64_tr_b16 v[138:139], v45 offset:1568
    ds_read_b64_tr_b16 v[140:141], v45 offset:10528
    ds_read_b64_tr_b16 v[142:143], v45 offset:11808
    s_waitcnt lgkmcnt(6)
    s_mov_b32 s35, 2155172
    v_mov_b32 v32, 36
Lw_45:
    s_sub_u32 s35, s35, 1
    s_cbranch_scc1 Lx_46
    ds_read_b32 v33, v32
    s_waitcnt lgkmcnt(0)
    v_readfirstlane_b32 s34, v33
    s_nop 0
    s_cmp_ge_u32 s34, 1
    s_cbranch_scc1 Lx_46
    s_sleep 2
    s_branch Lw_45
Lx_46:
    s_mov_b32 s29, s34
    s_mov_b32 s26, 0
    s_mov_b32 s93, 0
    s_mov_b32 s27, s28
    s_mov_b32 s28, 268435456
    s_mov_b32 s26, 268435456
    s_branch L_dgo2
L_dreal:
    s_mov_b64 exec, -1
    s_mov_b32 s28, s27
    s_mov_b32 s26, 0
    v_mov_b32 v144, 0
    v_mov_b32 v145, 0
    v_mov_b32 v146, 0
    v_mov_b32 v147, 0
    v_mov_b32 v148, 0
    v_mov_b32 v149, 0
    v_mov_b32 v150, 0
    v_mov_b32 v151, 0
    v_mov_b32 v152, 0
    v_mov_b32 v153, 0
    v_mov_b32 v154, 0
    v_mov_b32 v155, 0
    v_mov_b32 v156, 0
    v_mov_b32 v157, 0
    v_mov_b32 v158, 0
    v_mov_b32 v159, 0
    v_mov_b32 v160, 0
    v_mov_b32 v161, 0
    v_mov_b32 v162, 0
    v_mov_b32 v163, 0
    v_mov_b32 v164, 0
    v_mov_b32 v165, 0
    v_mov_b32 v166, 0
    v_mov_b32 v167, 0
    v_mov_b32 v168, 0
    v_mov_b32 v169, 0
    v_mov_b32 v170, 0
    v_mov_b32 v171, 0
    v_mov_b32 v172, 0
    v_mov_b32 v173, 0
    v_mov_b32 v174, 0
    v_mov_b32 v175, 0
    v_mov_b32 v176, 0
    v_mov_b32 v177, 0
    v_mov_b32 v178, 0
    v_mov_b32 v179, 0
    v_mov_b32 v180, 0
    v_mov_b32 v181, 0
    v_mov_b32 v182, 0
    v_mov_b32 v183, 0
    s_mov_b32 s35, 2155172
    v_mov_b32 v32, 24
Lw_47:
    s_sub_u32 s35, s35, 1
    s_cbranch_scc1 Lx_48
    ds_read_b32 v33, v32
    s_waitcnt lgkmcnt(0)
    v_readfirstlane_b32 s34, v33
    s_nop 0
    s_cmp_ge_u32 s34, 16843009
    s_cbranch_scc1 Lx_48
    s_sleep 2
    s_branch Lw_47
Lx_48:
    s_sleep 5
    s_mov_b32 s93, 2000000
L_dgo2:
    s_mov_b32 s35, s93
L_x3:
    ds_read_b32 v36, v5 offset:32
    ds_read_b128 v[16:19], v12 offset:4160
    ds_read_u16 v10, v6 offset:6400
    s_waitcnt lgkmcnt(0)
    v_cmp_ne_u32 vcc, s94, v36
    s_cbranch_vccz L_x3x
    s_sub_u32 s35, s35, 1
    s_cbranch_scc1 L_x3x
    s_branch L_x3
L_x3x:
    ds_read_u16 v50, v6 offset:29696
    v_smfmac_f32_16x16x64_bf16 v[144:147], v[16:19], v[64:71], v14
    v_smfmac_f32_16x16x64_bf16 v[148:151], v[16:19], v[72:79], v14
    v_smfmac_f32_16x16x64_bf16 v[152:155], v[16:19], v[80:87], v14
    v_smfmac_f32_16x16x64_bf16 v[156:159], v[16:19], v[88:95], v14
    v_smfmac_f32_16x16x64_bf16 v[160:163], v[16:19], v[96:103], v14
    v_smfmac_f32_16x16x64_bf16 v[164:167], v[16:19], v[104:111], v14
    v_smfmac_f32_16x16x64_bf16 v[168:171], v[16:19], v[112:119], v14
    s_nop 1
    v_add_f32 v24, v144, v145
    v_smfmac_f32_16x16x64_bf16 v[172:175], v[16:19], v[120:127], v14
    v_add_f32 v25, v148, v149
    v_smfmac_f32_16x16x64_bf16 v[176:179], v[16:19], v[128:135], v14
    v_add_f32 v26, v152, v153
    v_smfmac_f32_16x16x64_bf16 v[180:183], v[16:19], v[136:143], v14
    v_add_f32 v27, v156, v157
    v_bfi_b32 v24, s69, v47, v24
    v_bfi_b32 v25, s69, v47, v25
    v_bfi_b32 v26, s69, v47, v26
    v_bfi_b32 v27, s69, v47, v27
    v_add_f32 v28, v160, v161
    v_add_f32 v29, v164, v165
    v_add_f32 v30, v168, v169
    v_add_f32 v31, v172, v173
    v_add_f32 v32, v176, v177
    v_add_f32 v33, v180, v181
    v_bfi_b32 v28, s69, v48, v28
    v_bfi_b32 v29, s69, v48, v29
    v_bfi_b32 v30, s69, v48, v30
    v_bfi_b32 v31, s69, v48, v31
    v_bfi_b32 v32, s69, v49, v32
    v_bfi_b32 v33, s69, v49, v33
    s_mov_b64 exec, 0xffff
    s_cmp_eq_u32 s29, 2
    s_cbranch_scc0 L_zs
    buffer_store_dwordx4 v[24:27], v62, s[20:23], s28 offen
    buffer_store_dwordx4 v[28:31], v62, s[20:23], s28 offen offset:256
    buffer_store_dwordx2 v[32:33], v63, s[20:23], s28 offen offset:512
L_zd:
    s_mov_b64 exec, -1
    s_cmp_lt_u32 s32, 80
    s_cbranch_scc0 L_nored
    v_lshlrev_b32 v10, 16, v10
    s_waitcnt lgkmcnt(0)
    v_lshlrev_b32 v50, 16, v50
    s_mov_b32 s35, s93
L_rp:
    buffer_load_dwordx4 v[16:19], v0, s[20:23], s26 offen sc1
    s_waitcnt vmcnt(0)
    v_xor_b32 v36, v16, v7
    v_bitop3_b32 v36, v17, v7, v36 bitop3:0xbe
    v_bitop3_b32 v36, v18, v7, v36 bitop3:0xbe
    v_bitop3_b32 v36, v19, v7, v36 bitop3:0xbe
    v_and_b32 v36, s69, v36
    v_cmp_ne_u32 vcc, 0, v36
    v_permlane32_swap_b32 v16, v17
    v_permlane32_swap_b32 v18, v19
    s_sub_u32 s35, s35, 1
    s_cbranch_scc1 L_rpx
    s_cbranch_vccnz L_rp
L_rpx:
    v_add_f32 v16, v16, v17
    v_add_f32 v18, v18, v19
    s_nop 1
    v_permlane16_swap_b32 v16, v18
    v_add_f32 v16, v16, v18
    s_nop 1
    v_add_f32_dpp v16, v16, v16 row_ror:2 row_mask:0xf bank_mask:0xf
    s_nop 1
    v_add_f32_dpp v16, v16, v16 row_ror:4 row_mask:0xf bank_mask:0xf
    s_nop 1
    v_add_f32_dpp v16, v16, v16 row_ror:8 row_mask:0xf bank_mask:0xf
    v_fma_f32 v16, v50, v16, v10
    v_cvt_pk_bf16_f32 v16, v16, v16
    s_mov_b32 exec_lo, 0x00030003
    s_mov_b32 exec_hi, 0x00030003
    buffer_store_short v16, v6, s[12:15], s26 offen
L_nored:
    s_cmp_eq_u32 s93, 0
    s_cbranch_scc1 L_dreal
    s_cmp_eq_u32 s32, 0
    s_cbranch_scc0 L_r3e
    s_mov_b64 exec, 1
    v_mov_b32 v33, s64
    buffer_store_dword v33, v5, s[16:19], 0 offen offset:0
L_r3e:
L_end:
    s_endpgm
L_zs:
    buffer_store_dwordx4 v[24:27], v62, s[20:23], s28 offen sc1
    buffer_store_dwordx4 v[28:31], v62, s[20:23], s28 offen offset:256 sc1
    buffer_store_dwordx2 v[32:33], v63, s[20:23], s28 offen offset:512 sc1
    s_branch L_zd
L_codeend:
.section .rodata,"a"
.p2align 6
.amdhsa_kernel adaLN_cond__gqa_block_cached__swiglu_ffn__decode_kernel
.amdhsa_next_free_vgpr 256
.amdhsa_next_free_sgpr 102
.amdhsa_accum_offset 256
.amdhsa_group_segment_fixed_size 0
.amdhsa_kernarg_size 112
.amdhsa_user_sgpr_count 2
.amdhsa_user_sgpr_kernarg_segment_ptr 1
.amdhsa_system_sgpr_workgroup_id_x 1
.end_amdhsa_kernel
```
